```python
import torch

def _softmax(x, axis=-1):
    return torch.softmax(x, dim=axis)
def _gelu(x):
    return torch.nn.functional.gelu(x, approximate="tanh")
def _silu(x):
    return torch.nn.functional.silu(x)
def _sigmoid(x):
    return torch.sigmoid(x)
def _layernorm(x, axis=-1, eps=1e-5):
    m = x.mean(dim=axis, keepdim=True)
    v = x.var(dim=axis, keepdim=True, unbiased=False)
    return (x - m) / torch.sqrt(v + eps)
def _scatter_add(tgt, idx, src, axis=0):
    return tgt.clone().index_add_(axis, idx, src)
def _segment_sum(src, seg, n):
    out = torch.zeros((n,) + src.shape[1:], dtype=src.dtype)
    return out.index_add_(0, seg, src)
def _pad(x, pw):
    flat = tuple(v for pair in reversed(pw) for v in pair)
    return torch.nn.functional.pad(x, flat)

kernel_name = 'standalone__mha_softmax__near_ridge'

def setup_inputs():

    _w = (lambda a: (lambda t: t.to(torch.bfloat16) if t.is_floating_point() else t)(torch.as_tensor(a)))
    B, H, Sq, Sk, D = 32, 16, 256, 256, 256
    return {
        "q": _w((lambda *s: torch.randn(*s, dtype=torch.bfloat16) * 0.8)(B, H, Sq, D)),
        "k": _w((lambda *s: torch.randn(*s, dtype=torch.bfloat16) * 0.8)(B, H, Sk, D)),
        "v": _w((lambda *s: torch.randn(*s, dtype=torch.bfloat16) * 0.05)(B, H, Sk, D)),
    }

def reference(q, k, v):
    scale = q.shape[-1] ** -0.5
    scores = torch.einsum("bhqd,bhkd->bhqk", q, k) * scale
    p = _softmax(scores, axis=-1)
    return torch.einsum("bhqk,bhkd->bhqd", p, v)
```

```asm
; @launch grid=(256,1,1) block=(512,1,1) lds=163840
.amdgcn_target "amdgcn-amd-amdhsa--gfx950"
.text
.globl standalone__mha_softmax__near_ridge_kernel
.p2align 8
.type standalone__mha_softmax__near_ridge_kernel,@function
standalone__mha_softmax__near_ridge_kernel:
s_load_dwordx2 s[12:13], s[0:1], 0
s_cmpk_ge_u32 s2, 0x100
s_cbranch_scc1 L_end
v_readfirstlane_b32 s3, v0
v_bfe_u32 v42, v0, 3, 3
v_bfe_u32 v43, v0, 4, 2
v_xor_b32 v43, v43, v0
v_and_b32 v43, 7, v43
v_lshlrev_b32 v43, 4, v43
v_lshl_add_u32 v43, v42, 9, v43
s_mul_i32 s33, s2, 0x808004
s_and_b32 s33, s33, 0x3fc0100
v_lshl_add_u32 v10, s3, 8, v43
s_lshl_b32 s32, s3, 4
s_brev_b32 s14, 32
s_mov_b32 s15, 0x20000
s_add_u32 m0, s32, 131072
s_waitcnt lgkmcnt(0)
buffer_load_dwordx4 v10, s[12:15], s33 offen nt lds
s_load_dwordx2 s[16:17], s[0:1], 8
s_load_dwordx2 s[20:21], s[0:1], 16
s_load_dwordx2 s[24:25], s[0:1], 24
v_xor_b32 v11, 0x1040, v10
s_add_u32 m0, s32, 139264
s_xor_b32 s35, s33, 0
buffer_load_dwordx4 v11, s[12:15], s35 offen nt lds
s_add_u32 m0, s32, 147456
s_xor_b32 s35, s33, 8192
buffer_load_dwordx4 v10, s[12:15], s35 offen nt lds
s_lshr_b32 s3, s3, 6
v_lshrrev_b32 v40, 6, v0
v_and_b32 v41, 63, v0
v_lshl_add_u32 v12, v40, 12, v43
v_and_b32 v44, 64, v0
v_xor_b32 v12, v12, v44
s_lshl_b32 s60, s2, 13
s_and_b32 s60, s60, 0x18000
s_or_b32 s34, s33, s60
s_andn2_b32 s39, s33, 0x100
s_bfe_u32 s61, s2, 0x10003
s_lshl_b32 s61, s61, 7
s_or_b32 s39, s39, s61
s_and_b32 s61, s2, 1
s_lshl_b32 s61, s61, 8
s_or_b32 s39, s39, s61
s_or_b32 s36, s39, s60
s_mov_b32 s18, 0x4000000
s_mov_b32 s19, 0x20000
s_mov_b32 s22, 0x4000000
s_mov_b32 s23, 0x20000
s_mov_b32 s26, 0x4000000
s_mov_b32 s27, 0x20000
s_getpc_b64 s[64:65]
L_pf1:
s_add_u32 s64, s64, L_qa0+1024-L_pf1
s_addc_u32 s65, s65, 0
s_andn2_b32 s61, s2, 7
s_add_u32 s61, s61, s3
s_lshl_b32 s61, s61, 7
s_min_u32 s61, s61, L_end-(L_qa0+1024)
s_add_u32 s64, s64, s61
s_addc_u32 s65, s65, 0
v_mov_b32 v16, s64
v_mov_b32 v17, s65
global_load_dword v15, v[16:17], off
s_xor_b32 s72, s39, 0
s_xor_b32 s73, s39, 8192
s_xor_b32 s74, s39, 128
s_xor_b32 s75, s39, 8320
s_xor_b32 s76, s39, 256
s_xor_b32 s77, s39, 8448
s_xor_b32 s78, s39, 384
s_xor_b32 s79, s39, 8576
s_xor_b32 s80, s39, 131072
s_xor_b32 s81, s39, 139264
s_xor_b32 s82, s39, 131200
s_xor_b32 s83, s39, 139392
s_xor_b32 s84, s39, 131328
s_xor_b32 s85, s39, 139520
s_xor_b32 s86, s39, 131456
s_xor_b32 s87, s39, 139648
v_and_b32 v43, 7, v41
v_bfe_u32 v44, v41, 4, 1
v_xor_b32 v43, v43, v44
v_lshrrev_b32 v44, 5, v41
v_lshlrev_b32 v44, 2, v44
v_xor_b32 v43, v43, v44
v_lshlrev_b32 v43, 4, v43
v_lshl_add_u32 v43, v42, 9, v43
v_lshl_add_u32 v13, v40, 12, v43
v_lshrrev_b32 v43, 2, v41
v_lshlrev_b32 v43, 7, v43
v_bfe_u32 v44, v41, 1, 1
v_lshl_add_u32 v43, v44, 5, v43
v_bfe_u32 v44, v41, 0, 1
v_lshl_add_u32 v43, v44, 3, v43
v_bfe_u32 v44, v41, 3, 1
v_lshl_add_u32 v43, v44, 4, v43
v_bfe_u32 v44, v41, 4, 1
v_lshl_add_u32 v43, v44, 6, v43
v_xor_b32 v4, 0, v43
v_xor_b32 v5, 16, v43
v_xor_b32 v6, 64, v43
v_xor_b32 v7, 80, v43
v_and_b32 v44, 14, v41
v_lshlrev_b32 v43, 9, v44
v_lshl_add_u32 v43, v40, 14, v43
v_bfe_u32 v44, v41, 0, 1
v_lshl_add_u32 v43, v44, 4, v43
v_bfe_u32 v44, v41, 5, 1
v_lshl_add_u32 v43, v44, 5, v43
v_bfe_u32 v44, v41, 4, 1
v_lshl_add_u32 v43, v44, 6, v43
v_mov_b32 v14, v43
s_mov_b32 s62, 0x55555555
s_mov_b32 s63, 0x55555555
v_lshrrev_b32 v43, 4, v41
v_bfe_u32 v44, v41, 1, 3
v_xor_b32 v43, v43, v44
v_lshlrev_b32 v43, 4, v43
v_and_b32 v42, 7, v41
v_lshl_add_u32 v8, v42, 7, v43
v_lshl_add_u32 v8, v40, 10, v8
v_bfe_u32 v42, v41, 3, 1
v_lshl_add_u32 v8, v42, 13, v8
v_add_u32 v8, 0x20000, v8
v_xor_b32 v9, 64, v8
v_and_b32 v42, 15, v41
v_lshl_add_u32 v0, v42, 7, v43
v_xor_b32 v1, 0x40, v0
v_xor_b32 v2, 0x10000, v0
v_xor_b32 v3, 0x10040, v0
s_mov_b32 s37, 0x3db8aa3b
s_waitcnt lgkmcnt(0)
s_getreg_b32 s38, hwreg(HW_REG_XCC_ID, 0, 3)
L_qa0:
s_waitcnt vmcnt(3)
s_add_u32 m0, s32, 0
s_xor_b32 s35, s34, 0
buffer_load_dwordx4 v12, s[16:19], s35 offen nt lds
s_waitcnt vmcnt(3)
s_add_u32 m0, s32, 155648
s_xor_b32 s35, s33, 8192
buffer_load_dwordx4 v11, s[12:15], s35 offen nt lds
s_waitcnt vmcnt(3)
s_add_u32 m0, s32, 8192
s_xor_b32 s35, s34, 32768
buffer_load_dwordx4 v12, s[16:19], s35 offen nt lds
s_waitcnt vmcnt(2)
s_add_u32 m0, s32, 16384
s_xor_b32 s35, s34, 65536
buffer_load_dwordx4 v12, s[16:19], s35 offen nt lds
ds_read_b128 v[48:51], v8 offset:0
ds_read_b128 v[52:55], v9 offset:0
s_waitcnt vmcnt(2)
ds_read_b128 v[56:59], v8 offset:16384
ds_read_b128 v[60:63], v9 offset:16384
s_waitcnt lgkmcnt(2)
s_add_u32 m0, s32, 131072
s_xor_b32 s35, s33, 128
buffer_load_dwordx4 v10, s[12:15], s35 offen nt lds
s_waitcnt vmcnt(2)
s_barrier
ds_read_b128 v[24:27], v0 offset:0
s_waitcnt lgkmcnt(0)
ds_read_b128 v[28:31], v1 offset:0
s_waitcnt lgkmcnt(0)
v_mfma_f32_16x16x32_bf16 v[128:131], v[24:27], v[48:51], 0
v_mfma_f32_16x16x32_bf16 v[128:131], v[28:31], v[52:55], v[128:131]
v_mfma_f32_16x16x32_bf16 v[136:139], v[24:27], v[56:59], 0
v_mfma_f32_16x16x32_bf16 v[136:139], v[28:31], v[60:63], v[136:139]
ds_read_b128 v[32:35], v0 offset:2048
s_add_u32 m0, s32, 24576
s_xor_b32 s35, s34, 98304
buffer_load_dwordx4 v12, s[16:19], s35 offen nt lds
s_waitcnt lgkmcnt(0)
ds_read_b128 v[36:39], v1 offset:2048
s_waitcnt lgkmcnt(0)
v_mfma_f32_16x16x32_bf16 v[132:135], v[32:35], v[48:51], 0
v_mfma_f32_16x16x32_bf16 v[132:135], v[36:39], v[52:55], v[132:135]
v_mfma_f32_16x16x32_bf16 v[140:143], v[32:35], v[56:59], 0
v_mfma_f32_16x16x32_bf16 v[140:143], v[36:39], v[60:63], v[140:143]
ds_read_b128 v[40:43], v0 offset:4096
s_waitcnt vmcnt(2)
s_add_u32 m0, s32, 139264
s_xor_b32 s35, s33, 128
buffer_load_dwordx4 v11, s[12:15], s35 offen nt lds
s_waitcnt lgkmcnt(0)
ds_read_b128 v[44:47], v1 offset:4096
s_waitcnt lgkmcnt(0)
v_mfma_f32_16x16x32_bf16 v[144:147], v[40:43], v[48:51], 0
v_mfma_f32_16x16x32_bf16 v[144:147], v[44:47], v[52:55], v[144:147]
v_mfma_f32_16x16x32_bf16 v[152:155], v[40:43], v[56:59], 0
v_mfma_f32_16x16x32_bf16 v[152:155], v[44:47], v[60:63], v[152:155]
ds_read_b128 v[24:27], v0 offset:6144
s_waitcnt vmcnt(2)
s_add_u32 m0, s32, 32768
s_xor_b32 s35, s34, 128
buffer_load_dwordx4 v12, s[16:19], s35 offen nt lds
s_waitcnt lgkmcnt(0)
ds_read_b128 v[28:31], v1 offset:6144
s_waitcnt lgkmcnt(0)
v_mfma_f32_16x16x32_bf16 v[148:151], v[24:27], v[48:51], 0
v_mfma_f32_16x16x32_bf16 v[148:151], v[28:31], v[52:55], v[148:151]
v_mfma_f32_16x16x32_bf16 v[156:159], v[24:27], v[56:59], 0
v_mfma_f32_16x16x32_bf16 v[156:159], v[28:31], v[60:63], v[156:159]
ds_read_b128 v[32:35], v0 offset:8192
s_waitcnt vmcnt(2)
s_add_u32 m0, s32, 147456
s_xor_b32 s35, s33, 8320
buffer_load_dwordx4 v10, s[12:15], s35 offen nt lds
s_waitcnt lgkmcnt(0)
ds_read_b128 v[36:39], v1 offset:8192
s_waitcnt lgkmcnt(0)
v_mfma_f32_16x16x32_bf16 v[160:163], v[32:35], v[48:51], 0
v_mfma_f32_16x16x32_bf16 v[160:163], v[36:39], v[52:55], v[160:163]
v_mfma_f32_16x16x32_bf16 v[168:171], v[32:35], v[56:59], 0
v_mfma_f32_16x16x32_bf16 v[168:171], v[36:39], v[60:63], v[168:171]
ds_read_b128 v[40:43], v0 offset:10240
s_waitcnt vmcnt(2)
s_add_u32 m0, s32, 40960
s_xor_b32 s35, s34, 32896
buffer_load_dwordx4 v12, s[16:19], s35 offen nt lds
s_waitcnt lgkmcnt(0)
ds_read_b128 v[44:47], v1 offset:10240
s_waitcnt lgkmcnt(0)
v_mfma_f32_16x16x32_bf16 v[164:167], v[40:43], v[48:51], 0
v_mfma_f32_16x16x32_bf16 v[164:167], v[44:47], v[52:55], v[164:167]
v_mfma_f32_16x16x32_bf16 v[172:175], v[40:43], v[56:59], 0
v_mfma_f32_16x16x32_bf16 v[172:175], v[44:47], v[60:63], v[172:175]
ds_read_b128 v[24:27], v0 offset:12288
s_waitcnt lgkmcnt(0)
ds_read_b128 v[28:31], v1 offset:12288
s_waitcnt lgkmcnt(0)
v_mfma_f32_16x16x32_bf16 v[176:179], v[24:27], v[48:51], 0
v_mfma_f32_16x16x32_bf16 v[176:179], v[28:31], v[52:55], v[176:179]
v_mfma_f32_16x16x32_bf16 v[184:187], v[24:27], v[56:59], 0
v_mfma_f32_16x16x32_bf16 v[184:187], v[28:31], v[60:63], v[184:187]
ds_read_b128 v[32:35], v0 offset:14336
s_waitcnt vmcnt(2)
s_add_u32 m0, s32, 155648
s_xor_b32 s35, s33, 8320
buffer_load_dwordx4 v11, s[12:15], s35 offen nt lds
s_waitcnt lgkmcnt(0)
ds_read_b128 v[36:39], v1 offset:14336
s_waitcnt lgkmcnt(0)
v_mfma_f32_16x16x32_bf16 v[180:183], v[32:35], v[48:51], 0
v_mfma_f32_16x16x32_bf16 v[180:183], v[36:39], v[52:55], v[180:183]
v_mfma_f32_16x16x32_bf16 v[188:191], v[32:35], v[56:59], 0
v_mfma_f32_16x16x32_bf16 v[188:191], v[36:39], v[60:63], v[188:191]
s_barrier
ds_read_b128 v[40:43], v0 offset:16384
s_waitcnt lgkmcnt(0)
ds_read_b128 v[44:47], v1 offset:16384
s_waitcnt lgkmcnt(0)
v_mfma_f32_16x16x32_bf16 v[192:195], v[40:43], v[48:51], 0
v_mfma_f32_16x16x32_bf16 v[192:195], v[44:47], v[52:55], v[192:195]
v_mfma_f32_16x16x32_bf16 v[200:203], v[40:43], v[56:59], 0
v_mfma_f32_16x16x32_bf16 v[200:203], v[44:47], v[60:63], v[200:203]
ds_read_b128 v[24:27], v0 offset:18432
s_waitcnt vmcnt(2)
s_add_u32 m0, s32, 49152
s_xor_b32 s35, s34, 65664
buffer_load_dwordx4 v12, s[16:19], s35 offen nt lds
s_waitcnt lgkmcnt(0)
ds_read_b128 v[28:31], v1 offset:18432
s_waitcnt lgkmcnt(0)
v_mfma_f32_16x16x32_bf16 v[196:199], v[24:27], v[48:51], 0
v_mfma_f32_16x16x32_bf16 v[196:199], v[28:31], v[52:55], v[196:199]
v_mfma_f32_16x16x32_bf16 v[204:207], v[24:27], v[56:59], 0
v_mfma_f32_16x16x32_bf16 v[204:207], v[28:31], v[60:63], v[204:207]
ds_read_b128 v[32:35], v0 offset:20480
s_waitcnt lgkmcnt(0)
ds_read_b128 v[36:39], v1 offset:20480
s_waitcnt lgkmcnt(0)
v_mfma_f32_16x16x32_bf16 v[208:211], v[32:35], v[48:51], 0
v_mfma_f32_16x16x32_bf16 v[208:211], v[36:39], v[52:55], v[208:211]
v_mfma_f32_16x16x32_bf16 v[216:219], v[32:35], v[56:59], 0
v_mfma_f32_16x16x32_bf16 v[216:219], v[36:39], v[60:63], v[216:219]
ds_read_b128 v[40:43], v0 offset:22528
ds_read_b128 v[64:67], v8 offset:0
ds_read_b128 v[68:71], v9 offset:0
s_waitcnt lgkmcnt(0)
s_waitcnt vmcnt(2)
s_add_u32 m0, s32, 131072
s_xor_b32 s35, s33, 256
buffer_load_dwordx4 v10, s[12:15], s35 offen nt lds
ds_read_b128 v[44:47], v1 offset:22528
s_waitcnt lgkmcnt(0)
v_mfma_f32_16x16x32_bf16 v[212:215], v[40:43], v[48:51], 0
v_mfma_f32_16x16x32_bf16 v[212:215], v[44:47], v[52:55], v[212:215]
v_mfma_f32_16x16x32_bf16 v[220:223], v[40:43], v[56:59], 0
v_mfma_f32_16x16x32_bf16 v[220:223], v[44:47], v[60:63], v[220:223]
ds_read_b128 v[24:27], v0 offset:24576
s_waitcnt lgkmcnt(0)
ds_read_b128 v[28:31], v1 offset:24576
s_waitcnt lgkmcnt(0)
v_mfma_f32_16x16x32_bf16 v[224:227], v[24:27], v[48:51], 0
v_mfma_f32_16x16x32_bf16 v[224:227], v[28:31], v[52:55], v[224:227]
v_mfma_f32_16x16x32_bf16 v[232:235], v[24:27], v[56:59], 0
v_mfma_f32_16x16x32_bf16 v[232:235], v[28:31], v[60:63], v[232:235]
ds_read_b128 v[32:35], v0 offset:26624
s_waitcnt vmcnt(2)
s_add_u32 m0, s32, 57344
s_xor_b32 s35, s34, 98432
buffer_load_dwordx4 v12, s[16:19], s35 offen nt lds
s_waitcnt lgkmcnt(0)
ds_read_b128 v[36:39], v1 offset:26624
s_waitcnt lgkmcnt(0)
v_mfma_f32_16x16x32_bf16 v[228:231], v[32:35], v[48:51], 0
v_mfma_f32_16x16x32_bf16 v[228:231], v[36:39], v[52:55], v[228:231]
v_mfma_f32_16x16x32_bf16 v[236:239], v[32:35], v[56:59], 0
v_mfma_f32_16x16x32_bf16 v[236:239], v[36:39], v[60:63], v[236:239]
ds_read_b128 v[40:43], v0 offset:28672
s_waitcnt lgkmcnt(0)
ds_read_b128 v[44:47], v1 offset:28672
s_waitcnt lgkmcnt(0)
v_mfma_f32_16x16x32_bf16 v[240:243], v[40:43], v[48:51], 0
v_mfma_f32_16x16x32_bf16 v[240:243], v[44:47], v[52:55], v[240:243]
v_mfma_f32_16x16x32_bf16 v[248:251], v[40:43], v[56:59], 0
v_mfma_f32_16x16x32_bf16 v[248:251], v[44:47], v[60:63], v[248:251]
ds_read_b128 v[24:27], v0 offset:30720
s_waitcnt vmcnt(2)
s_add_u32 m0, s32, 139264
s_xor_b32 s35, s33, 256
buffer_load_dwordx4 v11, s[12:15], s35 offen nt lds
s_waitcnt lgkmcnt(0)
ds_read_b128 v[28:31], v1 offset:30720
s_waitcnt lgkmcnt(0)
v_mfma_f32_16x16x32_bf16 v[244:247], v[24:27], v[48:51], 0
v_mfma_f32_16x16x32_bf16 v[244:247], v[28:31], v[52:55], v[244:247]
v_mfma_f32_16x16x32_bf16 v[252:255], v[24:27], v[56:59], 0
v_mfma_f32_16x16x32_bf16 v[252:255], v[28:31], v[60:63], v[252:255]
ds_read_b128 v[72:75], v8 offset:16384
ds_read_b128 v[76:79], v9 offset:16384
s_barrier
ds_read_b128 v[32:35], v0 offset:32768
s_waitcnt lgkmcnt(0)
ds_read_b128 v[36:39], v1 offset:32768
s_waitcnt lgkmcnt(0)
v_mfma_f32_16x16x32_bf16 v[128:131], v[32:35], v[64:67], v[128:131]
v_mfma_f32_16x16x32_bf16 v[128:131], v[36:39], v[68:71], v[128:131]
v_mfma_f32_16x16x32_bf16 v[136:139], v[32:35], v[72:75], v[136:139]
v_mfma_f32_16x16x32_bf16 v[136:139], v[36:39], v[76:79], v[136:139]
ds_read_b128 v[40:43], v0 offset:34816
s_waitcnt vmcnt(2)
s_add_u32 m0, s32, 65536
s_xor_b32 s35, s34, 256
buffer_load_dwordx4 v12, s[16:19], s35 offen nt lds
s_waitcnt lgkmcnt(0)
ds_read_b128 v[44:47], v1 offset:34816
s_waitcnt lgkmcnt(0)
v_mfma_f32_16x16x32_bf16 v[132:135], v[40:43], v[64:67], v[132:135]
v_mfma_f32_16x16x32_bf16 v[132:135], v[44:47], v[68:71], v[132:135]
v_mfma_f32_16x16x32_bf16 v[140:143], v[40:43], v[72:75], v[140:143]
v_mfma_f32_16x16x32_bf16 v[140:143], v[44:47], v[76:79], v[140:143]
ds_read_b128 v[24:27], v0 offset:36864
s_waitcnt lgkmcnt(0)
ds_read_b128 v[28:31], v1 offset:36864
s_waitcnt lgkmcnt(0)
v_mfma_f32_16x16x32_bf16 v[144:147], v[24:27], v[64:67], v[144:147]
v_mfma_f32_16x16x32_bf16 v[144:147], v[28:31], v[68:71], v[144:147]
v_mfma_f32_16x16x32_bf16 v[152:155], v[24:27], v[72:75], v[152:155]
v_mfma_f32_16x16x32_bf16 v[152:155], v[28:31], v[76:79], v[152:155]
ds_read_b128 v[32:35], v0 offset:38912
s_waitcnt vmcnt(2)
s_add_u32 m0, s32, 147456
s_xor_b32 s35, s33, 8448
buffer_load_dwordx4 v10, s[12:15], s35 offen nt lds
s_waitcnt lgkmcnt(0)
ds_read_b128 v[36:39], v1 offset:38912
s_waitcnt lgkmcnt(0)
v_mfma_f32_16x16x32_bf16 v[148:151], v[32:35], v[64:67], v[148:151]
v_mfma_f32_16x16x32_bf16 v[148:151], v[36:39], v[68:71], v[148:151]
v_mfma_f32_16x16x32_bf16 v[156:159], v[32:35], v[72:75], v[156:159]
v_mfma_f32_16x16x32_bf16 v[156:159], v[36:39], v[76:79], v[156:159]
ds_read_b128 v[40:43], v0 offset:40960
s_waitcnt lgkmcnt(0)
ds_read_b128 v[44:47], v1 offset:40960
s_waitcnt lgkmcnt(0)
v_mfma_f32_16x16x32_bf16 v[160:163], v[40:43], v[64:67], v[160:163]
v_mfma_f32_16x16x32_bf16 v[160:163], v[44:47], v[68:71], v[160:163]
v_mfma_f32_16x16x32_bf16 v[168:171], v[40:43], v[72:75], v[168:171]
v_mfma_f32_16x16x32_bf16 v[168:171], v[44:47], v[76:79], v[168:171]
ds_read_b128 v[24:27], v0 offset:43008
s_waitcnt lgkmcnt(0)
ds_read_b128 v[28:31], v1 offset:43008
s_waitcnt lgkmcnt(0)
v_mfma_f32_16x16x32_bf16 v[164:167], v[24:27], v[64:67], v[164:167]
v_mfma_f32_16x16x32_bf16 v[164:167], v[28:31], v[68:71], v[164:167]
v_mfma_f32_16x16x32_bf16 v[172:175], v[24:27], v[72:75], v[172:175]
v_mfma_f32_16x16x32_bf16 v[172:175], v[28:31], v[76:79], v[172:175]
ds_read_b128 v[32:35], v0 offset:45056
s_waitcnt vmcnt(2)
s_add_u32 m0, s32, 73728
s_xor_b32 s35, s34, 33024
buffer_load_dwordx4 v12, s[16:19], s35 offen nt lds
s_waitcnt lgkmcnt(0)
ds_read_b128 v[36:39], v1 offset:45056
s_waitcnt lgkmcnt(0)
v_mfma_f32_16x16x32_bf16 v[176:179], v[32:35], v[64:67], v[176:179]
v_mfma_f32_16x16x32_bf16 v[176:179], v[36:39], v[68:71], v[176:179]
v_mfma_f32_16x16x32_bf16 v[184:187], v[32:35], v[72:75], v[184:187]
v_mfma_f32_16x16x32_bf16 v[184:187], v[36:39], v[76:79], v[184:187]
ds_read_b128 v[40:43], v0 offset:47104
s_waitcnt lgkmcnt(0)
ds_read_b128 v[44:47], v1 offset:47104
s_waitcnt lgkmcnt(0)
v_mfma_f32_16x16x32_bf16 v[180:183], v[40:43], v[64:67], v[180:183]
v_mfma_f32_16x16x32_bf16 v[180:183], v[44:47], v[68:71], v[180:183]
v_mfma_f32_16x16x32_bf16 v[188:191], v[40:43], v[72:75], v[188:191]
v_mfma_f32_16x16x32_bf16 v[188:191], v[44:47], v[76:79], v[188:191]
s_waitcnt vmcnt(2)
s_add_u32 m0, s32, 155648
s_xor_b32 s35, s33, 8448
buffer_load_dwordx4 v11, s[12:15], s35 offen nt lds
s_barrier
ds_read_b128 v[24:27], v0 offset:49152
s_waitcnt lgkmcnt(0)
ds_read_b128 v[28:31], v1 offset:49152
s_waitcnt lgkmcnt(0)
v_mfma_f32_16x16x32_bf16 v[192:195], v[24:27], v[64:67], v[192:195]
v_mfma_f32_16x16x32_bf16 v[192:195], v[28:31], v[68:71], v[192:195]
v_mfma_f32_16x16x32_bf16 v[200:203], v[24:27], v[72:75], v[200:203]
v_mfma_f32_16x16x32_bf16 v[200:203], v[28:31], v[76:79], v[200:203]
ds_read_b128 v[32:35], v0 offset:51200
s_waitcnt lgkmcnt(0)
ds_read_b128 v[36:39], v1 offset:51200
s_waitcnt lgkmcnt(0)
v_mfma_f32_16x16x32_bf16 v[196:199], v[32:35], v[64:67], v[196:199]
v_mfma_f32_16x16x32_bf16 v[196:199], v[36:39], v[68:71], v[196:199]
v_mfma_f32_16x16x32_bf16 v[204:207], v[32:35], v[72:75], v[204:207]
v_mfma_f32_16x16x32_bf16 v[204:207], v[36:39], v[76:79], v[204:207]
ds_read_b128 v[40:43], v0 offset:53248
s_waitcnt vmcnt(2)
s_add_u32 m0, s32, 81920
s_xor_b32 s35, s34, 65792
buffer_load_dwordx4 v12, s[16:19], s35 offen nt lds
s_waitcnt lgkmcnt(0)
ds_read_b128 v[44:47], v1 offset:53248
s_waitcnt lgkmcnt(0)
v_mfma_f32_16x16x32_bf16 v[208:211], v[40:43], v[64:67], v[208:211]
v_mfma_f32_16x16x32_bf16 v[208:211], v[44:47], v[68:71], v[208:211]
v_mfma_f32_16x16x32_bf16 v[216:219], v[40:43], v[72:75], v[216:219]
v_mfma_f32_16x16x32_bf16 v[216:219], v[44:47], v[76:79], v[216:219]
ds_read_b128 v[24:27], v0 offset:55296
s_waitcnt lgkmcnt(0)
ds_read_b128 v[28:31], v1 offset:55296
s_waitcnt lgkmcnt(0)
v_mfma_f32_16x16x32_bf16 v[212:215], v[24:27], v[64:67], v[212:215]
v_mfma_f32_16x16x32_bf16 v[212:215], v[28:31], v[68:71], v[212:215]
v_mfma_f32_16x16x32_bf16 v[220:223], v[24:27], v[72:75], v[220:223]
v_mfma_f32_16x16x32_bf16 v[220:223], v[28:31], v[76:79], v[220:223]
ds_read_b128 v[32:35], v0 offset:57344
ds_read_b128 v[48:51], v8 offset:0
ds_read_b128 v[52:55], v9 offset:0
s_waitcnt lgkmcnt(0)
s_waitcnt vmcnt(2)
s_add_u32 m0, s32, 131072
s_xor_b32 s35, s33, 384
buffer_load_dwordx4 v10, s[12:15], s35 offen nt lds
ds_read_b128 v[36:39], v1 offset:57344
s_waitcnt lgkmcnt(0)
v_mfma_f32_16x16x32_bf16 v[224:227], v[32:35], v[64:67], v[224:227]
v_mfma_f32_16x16x32_bf16 v[224:227], v[36:39], v[68:71], v[224:227]
v_mfma_f32_16x16x32_bf16 v[232:235], v[32:35], v[72:75], v[232:235]
v_mfma_f32_16x16x32_bf16 v[232:235], v[36:39], v[76:79], v[232:235]
ds_read_b128 v[40:43], v0 offset:59392
s_waitcnt lgkmcnt(0)
ds_read_b128 v[44:47], v1 offset:59392
s_waitcnt lgkmcnt(0)
v_mfma_f32_16x16x32_bf16 v[228:231], v[40:43], v[64:67], v[228:231]
v_mfma_f32_16x16x32_bf16 v[228:231], v[44:47], v[68:71], v[228:231]
v_mfma_f32_16x16x32_bf16 v[236:239], v[40:43], v[72:75], v[236:239]
v_mfma_f32_16x16x32_bf16 v[236:239], v[44:47], v[76:79], v[236:239]
ds_read_b128 v[24:27], v0 offset:61440
s_waitcnt lgkmcnt(0)
ds_read_b128 v[28:31], v1 offset:61440
s_waitcnt lgkmcnt(0)
v_mfma_f32_16x16x32_bf16 v[240:243], v[24:27], v[64:67], v[240:243]
v_mfma_f32_16x16x32_bf16 v[240:243], v[28:31], v[68:71], v[240:243]
v_mfma_f32_16x16x32_bf16 v[248:251], v[24:27], v[72:75], v[248:251]
v_mfma_f32_16x16x32_bf16 v[248:251], v[28:31], v[76:79], v[248:251]
ds_read_b128 v[32:35], v0 offset:63488
s_waitcnt vmcnt(2)
s_add_u32 m0, s32, 90112
s_xor_b32 s35, s34, 98560
buffer_load_dwordx4 v12, s[16:19], s35 offen nt lds
s_waitcnt lgkmcnt(0)
ds_read_b128 v[36:39], v1 offset:63488
s_waitcnt lgkmcnt(0)
v_mfma_f32_16x16x32_bf16 v[244:247], v[32:35], v[64:67], v[244:247]
v_mfma_f32_16x16x32_bf16 v[244:247], v[36:39], v[68:71], v[244:247]
v_mfma_f32_16x16x32_bf16 v[252:255], v[32:35], v[72:75], v[252:255]
v_mfma_f32_16x16x32_bf16 v[252:255], v[36:39], v[76:79], v[252:255]
ds_read_b128 v[56:59], v8 offset:16384
ds_read_b128 v[60:63], v9 offset:16384
s_barrier
ds_read_b128 v[40:43], v2 offset:0
s_waitcnt lgkmcnt(0)
ds_read_b128 v[44:47], v3 offset:0
s_waitcnt lgkmcnt(0)
v_mfma_f32_16x16x32_bf16 v[128:131], v[40:43], v[48:51], v[128:131]
v_mfma_f32_16x16x32_bf16 v[128:131], v[44:47], v[52:55], v[128:131]
v_mfma_f32_16x16x32_bf16 v[136:139], v[40:43], v[56:59], v[136:139]
v_mfma_f32_16x16x32_bf16 v[136:139], v[44:47], v[60:63], v[136:139]
ds_read_b128 v[24:27], v2 offset:2048
s_waitcnt vmcnt(2)
s_add_u32 m0, s32, 139264
s_xor_b32 s35, s33, 384
buffer_load_dwordx4 v11, s[12:15], s35 offen nt lds
s_waitcnt lgkmcnt(0)
ds_read_b128 v[28:31], v3 offset:2048
s_waitcnt lgkmcnt(0)
v_mfma_f32_16x16x32_bf16 v[132:135], v[24:27], v[48:51], v[132:135]
v_mfma_f32_16x16x32_bf16 v[132:135], v[28:31], v[52:55], v[132:135]
v_mfma_f32_16x16x32_bf16 v[140:143], v[24:27], v[56:59], v[140:143]
v_mfma_f32_16x16x32_bf16 v[140:143], v[28:31], v[60:63], v[140:143]
ds_read_b128 v[32:35], v2 offset:4096
s_waitcnt lgkmcnt(0)
ds_read_b128 v[36:39], v3 offset:4096
s_waitcnt lgkmcnt(0)
v_mfma_f32_16x16x32_bf16 v[144:147], v[32:35], v[48:51], v[144:147]
v_mfma_f32_16x16x32_bf16 v[144:147], v[36:39], v[52:55], v[144:147]
v_mfma_f32_16x16x32_bf16 v[152:155], v[32:35], v[56:59], v[152:155]
v_mfma_f32_16x16x32_bf16 v[152:155], v[36:39], v[60:63], v[152:155]
ds_read_b128 v[40:43], v2 offset:6144
s_waitcnt vmcnt(2)
s_add_u32 m0, s32, 98304
s_xor_b32 s35, s34, 384
buffer_load_dwordx4 v12, s[16:19], s35 offen nt lds
s_waitcnt lgkmcnt(0)
ds_read_b128 v[44:47], v3 offset:6144
s_waitcnt lgkmcnt(0)
v_mfma_f32_16x16x32_bf16 v[148:151], v[40:43], v[48:51], v[148:151]
v_mfma_f32_16x16x32_bf16 v[148:151], v[44:47], v[52:55], v[148:151]
v_mfma_f32_16x16x32_bf16 v[156:159], v[40:43], v[56:59], v[156:159]
v_mfma_f32_16x16x32_bf16 v[156:159], v[44:47], v[60:63], v[156:159]
ds_read_b128 v[24:27], v2 offset:8192
s_waitcnt lgkmcnt(0)
ds_read_b128 v[28:31], v3 offset:8192
s_waitcnt lgkmcnt(0)
v_mfma_f32_16x16x32_bf16 v[160:163], v[24:27], v[48:51], v[160:163]
v_mfma_f32_16x16x32_bf16 v[160:163], v[28:31], v[52:55], v[160:163]
v_mfma_f32_16x16x32_bf16 v[168:171], v[24:27], v[56:59], v[168:171]
v_mfma_f32_16x16x32_bf16 v[168:171], v[28:31], v[60:63], v[168:171]
ds_read_b128 v[32:35], v2 offset:10240
s_waitcnt lgkmcnt(0)
ds_read_b128 v[36:39], v3 offset:10240
s_waitcnt lgkmcnt(0)
v_mfma_f32_16x16x32_bf16 v[164:167], v[32:35], v[48:51], v[164:167]
v_mfma_f32_16x16x32_bf16 v[164:167], v[36:39], v[52:55], v[164:167]
v_mfma_f32_16x16x32_bf16 v[172:175], v[32:35], v[56:59], v[172:175]
v_mfma_f32_16x16x32_bf16 v[172:175], v[36:39], v[60:63], v[172:175]
ds_read_b128 v[40:43], v2 offset:12288
s_waitcnt vmcnt(2)
s_add_u32 m0, s32, 147456
s_xor_b32 s35, s33, 8576
buffer_load_dwordx4 v10, s[12:15], s35 offen nt lds
s_waitcnt lgkmcnt(0)
ds_read_b128 v[44:47], v3 offset:12288
s_waitcnt lgkmcnt(0)
v_mfma_f32_16x16x32_bf16 v[176:179], v[40:43], v[48:51], v[176:179]
v_mfma_f32_16x16x32_bf16 v[176:179], v[44:47], v[52:55], v[176:179]
v_mfma_f32_16x16x32_bf16 v[184:187], v[40:43], v[56:59], v[184:187]
v_mfma_f32_16x16x32_bf16 v[184:187], v[44:47], v[60:63], v[184:187]
ds_read_b128 v[24:27], v2 offset:14336
s_waitcnt lgkmcnt(0)
ds_read_b128 v[28:31], v3 offset:14336
s_waitcnt lgkmcnt(0)
v_mfma_f32_16x16x32_bf16 v[180:183], v[24:27], v[48:51], v[180:183]
v_mfma_f32_16x16x32_bf16 v[180:183], v[28:31], v[52:55], v[180:183]
v_mfma_f32_16x16x32_bf16 v[188:191], v[24:27], v[56:59], v[188:191]
v_mfma_f32_16x16x32_bf16 v[188:191], v[28:31], v[60:63], v[188:191]
s_waitcnt vmcnt(2)
s_add_u32 m0, s32, 106496
s_xor_b32 s35, s34, 33152
buffer_load_dwordx4 v12, s[16:19], s35 offen nt lds
s_barrier
ds_read_b128 v[32:35], v2 offset:16384
s_waitcnt lgkmcnt(0)
ds_read_b128 v[36:39], v3 offset:16384
s_waitcnt lgkmcnt(0)
v_mfma_f32_16x16x32_bf16 v[192:195], v[32:35], v[48:51], v[192:195]
v_mfma_f32_16x16x32_bf16 v[192:195], v[36:39], v[52:55], v[192:195]
v_mfma_f32_16x16x32_bf16 v[200:203], v[32:35], v[56:59], v[200:203]
v_mfma_f32_16x16x32_bf16 v[200:203], v[36:39], v[60:63], v[200:203]
ds_read_b128 v[40:43], v2 offset:18432
s_waitcnt lgkmcnt(0)
ds_read_b128 v[44:47], v3 offset:18432
s_waitcnt lgkmcnt(0)
v_mfma_f32_16x16x32_bf16 v[196:199], v[40:43], v[48:51], v[196:199]
v_mfma_f32_16x16x32_bf16 v[196:199], v[44:47], v[52:55], v[196:199]
v_mfma_f32_16x16x32_bf16 v[204:207], v[40:43], v[56:59], v[204:207]
v_mfma_f32_16x16x32_bf16 v[204:207], v[44:47], v[60:63], v[204:207]
ds_read_b128 v[24:27], v2 offset:20480
s_waitcnt vmcnt(2)
s_add_u32 m0, s32, 155648
s_xor_b32 s35, s33, 8576
buffer_load_dwordx4 v11, s[12:15], s35 offen nt lds
s_waitcnt lgkmcnt(0)
ds_read_b128 v[28:31], v3 offset:20480
s_waitcnt lgkmcnt(0)
v_mfma_f32_16x16x32_bf16 v[208:211], v[24:27], v[48:51], v[208:211]
v_mfma_f32_16x16x32_bf16 v[208:211], v[28:31], v[52:55], v[208:211]
v_mfma_f32_16x16x32_bf16 v[216:219], v[24:27], v[56:59], v[216:219]
v_mfma_f32_16x16x32_bf16 v[216:219], v[28:31], v[60:63], v[216:219]
ds_read_b128 v[32:35], v2 offset:22528
s_waitcnt lgkmcnt(0)
ds_read_b128 v[36:39], v3 offset:22528
s_waitcnt lgkmcnt(0)
v_mfma_f32_16x16x32_bf16 v[212:215], v[32:35], v[48:51], v[212:215]
v_mfma_f32_16x16x32_bf16 v[212:215], v[36:39], v[52:55], v[212:215]
v_mfma_f32_16x16x32_bf16 v[220:223], v[32:35], v[56:59], v[220:223]
v_mfma_f32_16x16x32_bf16 v[220:223], v[36:39], v[60:63], v[220:223]
ds_read_b128 v[40:43], v2 offset:24576
s_waitcnt vmcnt(2)
s_add_u32 m0, s32, 114688
s_xor_b32 s35, s34, 65920
buffer_load_dwordx4 v12, s[16:19], s35 offen nt lds
s_waitcnt lgkmcnt(0)
ds_read_b128 v[44:47], v3 offset:24576
s_waitcnt lgkmcnt(0)
v_mfma_f32_16x16x32_bf16 v[224:227], v[40:43], v[48:51], v[224:227]
v_mfma_f32_16x16x32_bf16 v[224:227], v[44:47], v[52:55], v[224:227]
v_mfma_f32_16x16x32_bf16 v[232:235], v[40:43], v[56:59], v[232:235]
v_mfma_f32_16x16x32_bf16 v[232:235], v[44:47], v[60:63], v[232:235]
ds_read_b128 v[24:27], v2 offset:26624
s_waitcnt lgkmcnt(0)
ds_read_b128 v[28:31], v3 offset:26624
s_waitcnt lgkmcnt(0)
v_mfma_f32_16x16x32_bf16 v[228:231], v[24:27], v[48:51], v[228:231]
v_mfma_f32_16x16x32_bf16 v[228:231], v[28:31], v[52:55], v[228:231]
v_mfma_f32_16x16x32_bf16 v[236:239], v[24:27], v[56:59], v[236:239]
v_mfma_f32_16x16x32_bf16 v[236:239], v[28:31], v[60:63], v[236:239]
ds_read_b128 v[32:35], v2 offset:28672
s_waitcnt lgkmcnt(0)
ds_read_b128 v[36:39], v3 offset:28672
s_waitcnt lgkmcnt(0)
v_mfma_f32_16x16x32_bf16 v[240:243], v[32:35], v[48:51], v[240:243]
v_mfma_f32_16x16x32_bf16 v[240:243], v[36:39], v[52:55], v[240:243]
v_mfma_f32_16x16x32_bf16 v[248:251], v[32:35], v[56:59], v[248:251]
v_mfma_f32_16x16x32_bf16 v[248:251], v[36:39], v[60:63], v[248:251]
ds_read_b128 v[40:43], v2 offset:30720
s_waitcnt vmcnt(2)
s_add_u32 m0, s32, 122880
s_xor_b32 s35, s34, 98688
buffer_load_dwordx4 v12, s[16:19], s35 offen nt lds
s_waitcnt lgkmcnt(0)
ds_read_b128 v[44:47], v3 offset:30720
s_waitcnt lgkmcnt(0)
v_mfma_f32_16x16x32_bf16 v[244:247], v[40:43], v[48:51], v[244:247]
v_mfma_f32_16x16x32_bf16 v[244:247], v[44:47], v[52:55], v[244:247]
v_mfma_f32_16x16x32_bf16 v[252:255], v[40:43], v[56:59], v[252:255]
v_mfma_f32_16x16x32_bf16 v[252:255], v[44:47], v[60:63], v[252:255]
ds_read_b128 v[64:67], v8 offset:0
ds_read_b128 v[68:71], v9 offset:0
s_waitcnt vmcnt(2)
ds_read_b128 v[72:75], v8 offset:16384
ds_read_b128 v[76:79], v9 offset:16384
s_barrier
ds_read_b128 v[24:27], v2 offset:32768
s_waitcnt lgkmcnt(0)
ds_read_b128 v[28:31], v3 offset:32768
s_waitcnt lgkmcnt(0)
v_mfma_f32_16x16x32_bf16 v[128:131], v[24:27], v[64:67], v[128:131]
v_mfma_f32_16x16x32_bf16 v[128:131], v[28:31], v[68:71], v[128:131]
v_mfma_f32_16x16x32_bf16 v[136:139], v[24:27], v[72:75], v[136:139]
v_mfma_f32_16x16x32_bf16 v[136:139], v[28:31], v[76:79], v[136:139]
ds_read_b128 v[32:35], v2 offset:34816
s_add_u32 m0, s32, 0
s_xor_b32 s35, s36, 0
buffer_load_dwordx4 v13, s[20:23], s35 offen nt lds
s_waitcnt lgkmcnt(0)
ds_read_b128 v[36:39], v3 offset:34816
s_waitcnt lgkmcnt(0)
v_mfma_f32_16x16x32_bf16 v[132:135], v[32:35], v[64:67], v[132:135]
v_mfma_f32_16x16x32_bf16 v[132:135], v[36:39], v[68:71], v[132:135]
v_mfma_f32_16x16x32_bf16 v[140:143], v[32:35], v[72:75], v[140:143]
v_mfma_f32_16x16x32_bf16 v[140:143], v[36:39], v[76:79], v[140:143]
ds_read_b128 v[40:43], v2 offset:36864
s_waitcnt lgkmcnt(0)
ds_read_b128 v[44:47], v3 offset:36864
s_waitcnt lgkmcnt(0)
v_mfma_f32_16x16x32_bf16 v[144:147], v[40:43], v[64:67], v[144:147]
v_mfma_f32_16x16x32_bf16 v[144:147], v[44:47], v[68:71], v[144:147]
v_mfma_f32_16x16x32_bf16 v[152:155], v[40:43], v[72:75], v[152:155]
v_mfma_f32_16x16x32_bf16 v[152:155], v[44:47], v[76:79], v[152:155]
ds_read_b128 v[24:27], v2 offset:38912
v_max_f32 v16, v128, v129
v_max_f32 v17, v136, v137
s_waitcnt vmcnt(2)
s_add_u32 m0, s32, 8192
s_xor_b32 s35, s36, 32768
buffer_load_dwordx4 v13, s[20:23], s35 offen nt lds
s_waitcnt lgkmcnt(0)
ds_read_b128 v[28:31], v3 offset:38912
s_waitcnt lgkmcnt(0)
v_mfma_f32_16x16x32_bf16 v[148:151], v[24:27], v[64:67], v[148:151]
v_mfma_f32_16x16x32_bf16 v[148:151], v[28:31], v[68:71], v[148:151]
v_max3_f32 v16, v16, v130, v131
v_max3_f32 v17, v17, v138, v139
v_mfma_f32_16x16x32_bf16 v[156:159], v[24:27], v[72:75], v[156:159]
v_mfma_f32_16x16x32_bf16 v[156:159], v[28:31], v[76:79], v[156:159]
ds_read_b128 v[32:35], v2 offset:40960
v_max3_f32 v16, v16, v132, v133
v_max3_f32 v17, v17, v140, v141
s_waitcnt lgkmcnt(0)
ds_read_b128 v[36:39], v3 offset:40960
s_waitcnt lgkmcnt(0)
v_mfma_f32_16x16x32_bf16 v[160:163], v[32:35], v[64:67], v[160:163]
v_mfma_f32_16x16x32_bf16 v[160:163], v[36:39], v[68:71], v[160:163]
v_max3_f32 v16, v16, v134, v135
v_max3_f32 v17, v17, v142, v143
v_mfma_f32_16x16x32_bf16 v[168:171], v[32:35], v[72:75], v[168:171]
v_mfma_f32_16x16x32_bf16 v[168:171], v[36:39], v[76:79], v[168:171]
ds_read_b128 v[40:43], v2 offset:43008
v_max3_f32 v16, v16, v144, v145
v_max3_f32 v17, v17, v152, v153
s_waitcnt lgkmcnt(0)
ds_read_b128 v[44:47], v3 offset:43008
s_waitcnt lgkmcnt(0)
v_mfma_f32_16x16x32_bf16 v[164:167], v[40:43], v[64:67], v[164:167]
v_mfma_f32_16x16x32_bf16 v[164:167], v[44:47], v[68:71], v[164:167]
v_max3_f32 v16, v16, v146, v147
v_max3_f32 v17, v17, v154, v155
v_mfma_f32_16x16x32_bf16 v[172:175], v[40:43], v[72:75], v[172:175]
v_mfma_f32_16x16x32_bf16 v[172:175], v[44:47], v[76:79], v[172:175]
ds_read_b128 v[24:27], v2 offset:45056
v_max3_f32 v16, v16, v148, v149
v_max3_f32 v17, v17, v156, v157
s_waitcnt vmcnt(2)
s_add_u32 m0, s32, 16384
s_xor_b32 s35, s36, 65536
buffer_load_dwordx4 v13, s[20:23], s35 offen nt lds
s_waitcnt lgkmcnt(0)
ds_read_b128 v[28:31], v3 offset:45056
s_waitcnt lgkmcnt(0)
v_mfma_f32_16x16x32_bf16 v[176:179], v[24:27], v[64:67], v[176:179]
v_mfma_f32_16x16x32_bf16 v[176:179], v[28:31], v[68:71], v[176:179]
v_max3_f32 v16, v16, v150, v151
v_max3_f32 v17, v17, v158, v159
v_mfma_f32_16x16x32_bf16 v[184:187], v[24:27], v[72:75], v[184:187]
v_mfma_f32_16x16x32_bf16 v[184:187], v[28:31], v[76:79], v[184:187]
ds_read_b128 v[32:35], v2 offset:47104
v_max3_f32 v16, v16, v160, v161
v_max3_f32 v17, v17, v168, v169
s_waitcnt lgkmcnt(0)
ds_read_b128 v[36:39], v3 offset:47104
s_waitcnt lgkmcnt(0)
v_mfma_f32_16x16x32_bf16 v[180:183], v[32:35], v[64:67], v[180:183]
v_mfma_f32_16x16x32_bf16 v[180:183], v[36:39], v[68:71], v[180:183]
v_max3_f32 v16, v16, v162, v163
v_max3_f32 v17, v17, v170, v171
v_mfma_f32_16x16x32_bf16 v[188:191], v[32:35], v[72:75], v[188:191]
v_mfma_f32_16x16x32_bf16 v[188:191], v[36:39], v[76:79], v[188:191]
v_max3_f32 v16, v16, v164, v165
v_max3_f32 v17, v17, v172, v173
s_waitcnt vmcnt(2)
s_add_u32 m0, s32, 24576
s_xor_b32 s35, s36, 98304
buffer_load_dwordx4 v13, s[20:23], s35 offen nt lds
s_barrier
ds_read_b128 v[40:43], v2 offset:49152
s_waitcnt lgkmcnt(0)
ds_read_b128 v[44:47], v3 offset:49152
s_waitcnt lgkmcnt(0)
v_mfma_f32_16x16x32_bf16 v[192:195], v[40:43], v[64:67], v[192:195]
v_mfma_f32_16x16x32_bf16 v[192:195], v[44:47], v[68:71], v[192:195]
v_max3_f32 v16, v16, v166, v167
v_max3_f32 v17, v17, v174, v175
v_mfma_f32_16x16x32_bf16 v[200:203], v[40:43], v[72:75], v[200:203]
v_mfma_f32_16x16x32_bf16 v[200:203], v[44:47], v[76:79], v[200:203]
ds_read_b128 v[24:27], v2 offset:51200
v_max3_f32 v16, v16, v176, v177
v_max3_f32 v17, v17, v184, v185
s_waitcnt lgkmcnt(0)
ds_read_b128 v[28:31], v3 offset:51200
s_waitcnt lgkmcnt(0)
v_mfma_f32_16x16x32_bf16 v[196:199], v[24:27], v[64:67], v[196:199]
v_mfma_f32_16x16x32_bf16 v[196:199], v[28:31], v[68:71], v[196:199]
v_max3_f32 v16, v16, v178, v179
v_max3_f32 v17, v17, v186, v187
v_mfma_f32_16x16x32_bf16 v[204:207], v[24:27], v[72:75], v[204:207]
v_mfma_f32_16x16x32_bf16 v[204:207], v[28:31], v[76:79], v[204:207]
ds_read_b128 v[32:35], v2 offset:53248
v_max3_f32 v16, v16, v180, v181
v_max3_f32 v17, v17, v188, v189
s_waitcnt vmcnt(2)
s_add_u32 m0, s32, 32768
s_xor_b32 s35, s36, 128
buffer_load_dwordx4 v13, s[20:23], s35 offen nt lds
s_waitcnt lgkmcnt(0)
ds_read_b128 v[36:39], v3 offset:53248
s_waitcnt lgkmcnt(0)
v_mfma_f32_16x16x32_bf16 v[208:211], v[32:35], v[64:67], v[208:211]
v_mfma_f32_16x16x32_bf16 v[208:211], v[36:39], v[68:71], v[208:211]
v_max3_f32 v16, v16, v182, v183
v_max3_f32 v17, v17, v190, v191
v_mfma_f32_16x16x32_bf16 v[216:219], v[32:35], v[72:75], v[216:219]
v_mfma_f32_16x16x32_bf16 v[216:219], v[36:39], v[76:79], v[216:219]
ds_read_b128 v[40:43], v2 offset:55296
v_max3_f32 v16, v16, v192, v193
v_max3_f32 v17, v17, v200, v201
s_waitcnt lgkmcnt(0)
ds_read_b128 v[44:47], v3 offset:55296
s_waitcnt lgkmcnt(0)
v_mfma_f32_16x16x32_bf16 v[212:215], v[40:43], v[64:67], v[212:215]
v_mfma_f32_16x16x32_bf16 v[212:215], v[44:47], v[68:71], v[212:215]
v_max3_f32 v16, v16, v194, v195
v_max3_f32 v17, v17, v202, v203
v_mfma_f32_16x16x32_bf16 v[220:223], v[40:43], v[72:75], v[220:223]
v_mfma_f32_16x16x32_bf16 v[220:223], v[44:47], v[76:79], v[220:223]
ds_read_b128 v[24:27], v2 offset:57344
v_max3_f32 v16, v16, v196, v197
v_max3_f32 v17, v17, v204, v205
s_waitcnt vmcnt(2)
s_add_u32 m0, s32, 40960
s_xor_b32 s35, s36, 32896
buffer_load_dwordx4 v13, s[20:23], s35 offen nt lds
s_waitcnt lgkmcnt(0)
ds_read_b128 v[28:31], v3 offset:57344
s_waitcnt lgkmcnt(0)
v_mfma_f32_16x16x32_bf16 v[224:227], v[24:27], v[64:67], v[224:227]
v_mfma_f32_16x16x32_bf16 v[224:227], v[28:31], v[68:71], v[224:227]
v_max3_f32 v16, v16, v198, v199
v_max3_f32 v17, v17, v206, v207
v_mfma_f32_16x16x32_bf16 v[232:235], v[24:27], v[72:75], v[232:235]
v_mfma_f32_16x16x32_bf16 v[232:235], v[28:31], v[76:79], v[232:235]
ds_read_b128 v[32:35], v2 offset:59392
v_max3_f32 v16, v16, v208, v209
v_max3_f32 v17, v17, v216, v217
s_waitcnt lgkmcnt(0)
ds_read_b128 v[36:39], v3 offset:59392
s_waitcnt lgkmcnt(0)
v_mfma_f32_16x16x32_bf16 v[228:231], v[32:35], v[64:67], v[228:231]
v_mfma_f32_16x16x32_bf16 v[228:231], v[36:39], v[68:71], v[228:231]
v_max3_f32 v16, v16, v210, v211
v_max3_f32 v17, v17, v218, v219
v_mfma_f32_16x16x32_bf16 v[236:239], v[32:35], v[72:75], v[236:239]
v_mfma_f32_16x16x32_bf16 v[236:239], v[36:39], v[76:79], v[236:239]
ds_read_b128 v[40:43], v2 offset:61440
v_max3_f32 v16, v16, v212, v213
v_max3_f32 v17, v17, v220, v221
s_waitcnt lgkmcnt(0)
ds_read_b128 v[44:47], v3 offset:61440
s_waitcnt lgkmcnt(0)
v_mfma_f32_16x16x32_bf16 v[240:243], v[40:43], v[64:67], v[240:243]
v_mfma_f32_16x16x32_bf16 v[240:243], v[44:47], v[68:71], v[240:243]
v_max3_f32 v16, v16, v214, v215
v_max3_f32 v17, v17, v222, v223
v_mfma_f32_16x16x32_bf16 v[248:251], v[40:43], v[72:75], v[248:251]
v_mfma_f32_16x16x32_bf16 v[248:251], v[44:47], v[76:79], v[248:251]
ds_read_b128 v[24:27], v2 offset:63488
v_max3_f32 v16, v16, v224, v225
v_max3_f32 v17, v17, v232, v233
s_waitcnt vmcnt(2)
s_add_u32 m0, s32, 49152
s_xor_b32 s35, s36, 65664
buffer_load_dwordx4 v13, s[20:23], s35 offen nt lds
s_waitcnt lgkmcnt(0)
ds_read_b128 v[28:31], v3 offset:63488
s_waitcnt lgkmcnt(0)
v_mfma_f32_16x16x32_bf16 v[244:247], v[24:27], v[64:67], v[244:247]
v_mfma_f32_16x16x32_bf16 v[244:247], v[28:31], v[68:71], v[244:247]
v_max3_f32 v16, v16, v226, v227
v_max3_f32 v17, v17, v234, v235
v_mfma_f32_16x16x32_bf16 v[252:255], v[24:27], v[72:75], v[252:255]
v_mfma_f32_16x16x32_bf16 v[252:255], v[28:31], v[76:79], v[252:255]
v_max3_f32 v16, v16, v228, v229
v_max3_f32 v17, v17, v236, v237
v_max3_f32 v16, v16, v230, v231
v_max3_f32 v17, v17, v238, v239
.p2align 3
L_qa_join:
s_barrier
ds_read_b64_tr_b16 v[24:25], v4 offset:0
ds_read_b64_tr_b16 v[26:27], v4 offset:2048
ds_read_b64_tr_b16 v[28:29], v4 offset:4096
ds_read_b64_tr_b16 v[30:31], v4 offset:6144
ds_read_b64_tr_b16 v[32:33], v5 offset:0
ds_read_b64_tr_b16 v[34:35], v5 offset:2048
ds_read_b64_tr_b16 v[36:37], v5 offset:4096
ds_read_b64_tr_b16 v[38:39], v5 offset:6144
v_max3_f32 v16, v16, v240, v241
v_max3_f32 v17, v17, v248, v249
v_max3_f32 v16, v16, v242, v243
v_max3_f32 v17, v17, v250, v251
v_max3_f32 v16, v16, v244, v245
v_max3_f32 v17, v17, v252, v253
v_max3_f32 v16, v16, v246, v247
v_max3_f32 v17, v17, v254, v255
s_nop 1
v_permlane32_swap_b32 v16, v17
v_mov_b32 v80, 0x3f803f80
v_max_f32 v16, v16, v17
v_mov_b32 v17, v16
v_mov_b32 v81, 0x3f803f80
v_mov_b32 v82, 0x3f803f80
v_permlane16_swap_b32 v16, v17
v_mov_b32 v83, 0x3f803f80
v_max_f32 v16, v16, v17
v_mul_f32 v16, s37, v16
v_mov_b32 v17, v16
s_nop 1
v_permlane32_swap_b32 v16, v17
s_nop 0
v_fma_f32 v128, v128, s37, -v16
v_fma_f32 v129, v129, s37, -v16
v_exp_f32 v128, v128
v_fma_f32 v130, v130, s37, -v16
v_exp_f32 v129, v129
v_fma_f32 v131, v131, s37, -v16
v_exp_f32 v130, v130
v_cvt_pk_bf16_f32 v128, v128, v129
v_fma_f32 v132, v132, s37, -v16
v_exp_f32 v131, v131
v_fma_f32 v133, v133, s37, -v16
v_exp_f32 v132, v132
v_cvt_pk_bf16_f32 v129, v130, v131
v_fma_f32 v134, v134, s37, -v16
v_exp_f32 v133, v133
v_fma_f32 v135, v135, s37, -v16
v_exp_f32 v134, v134
v_cvt_pk_bf16_f32 v130, v132, v133
v_fma_f32 v136, v136, s37, -v17
v_exp_f32 v135, v135
v_fma_f32 v137, v137, s37, -v17
v_exp_f32 v136, v136
v_cvt_pk_bf16_f32 v131, v134, v135
s_add_u32 m0, s32, 57344
s_xor_b32 s35, s36, 98432
buffer_load_dwordx4 v13, s[20:23], s35 offen nt lds
v_fma_f32 v138, v138, s37, -v17
v_exp_f32 v137, v137
v_fma_f32 v139, v139, s37, -v17
v_exp_f32 v138, v138
v_cvt_pk_bf16_f32 v132, v136, v137
v_fma_f32 v140, v140, s37, -v17
v_exp_f32 v139, v139
v_fma_f32 v141, v141, s37, -v17
v_exp_f32 v140, v140
v_cvt_pk_bf16_f32 v133, v138, v139
v_fma_f32 v142, v142, s37, -v17
v_exp_f32 v141, v141
v_fma_f32 v143, v143, s37, -v17
v_exp_f32 v142, v142
v_cvt_pk_bf16_f32 v134, v140, v141
v_fma_f32 v144, v144, s37, -v16
v_exp_f32 v143, v143
v_fma_f32 v145, v145, s37, -v16
v_exp_f32 v144, v144
v_cvt_pk_bf16_f32 v135, v142, v143
v_fma_f32 v146, v146, s37, -v16
v_exp_f32 v145, v145
v_fma_f32 v147, v147, s37, -v16
v_exp_f32 v146, v146
v_cvt_pk_bf16_f32 v136, v144, v145
v_fma_f32 v148, v148, s37, -v16
v_exp_f32 v147, v147
v_fma_f32 v149, v149, s37, -v16
v_exp_f32 v148, v148
v_cvt_pk_bf16_f32 v137, v146, v147
v_fma_f32 v150, v150, s37, -v16
v_exp_f32 v149, v149
v_fma_f32 v151, v151, s37, -v16
v_exp_f32 v150, v150
v_cvt_pk_bf16_f32 v138, v148, v149
v_fma_f32 v152, v152, s37, -v17
v_exp_f32 v151, v151
v_fma_f32 v153, v153, s37, -v17
v_exp_f32 v152, v152
v_cvt_pk_bf16_f32 v139, v150, v151
s_add_u32 m0, s32, 65536
s_xor_b32 s35, s36, 256
buffer_load_dwordx4 v13, s[20:23], s35 offen nt lds
v_fma_f32 v154, v154, s37, -v17
v_exp_f32 v153, v153
v_fma_f32 v155, v155, s37, -v17
v_exp_f32 v154, v154
v_cvt_pk_bf16_f32 v140, v152, v153
v_fma_f32 v156, v156, s37, -v17
v_exp_f32 v155, v155
v_fma_f32 v157, v157, s37, -v17
v_exp_f32 v156, v156
v_cvt_pk_bf16_f32 v141, v154, v155
v_fma_f32 v158, v158, s37, -v17
v_exp_f32 v157, v157
v_fma_f32 v159, v159, s37, -v17
v_exp_f32 v158, v158
v_cvt_pk_bf16_f32 v142, v156, v157
v_fma_f32 v160, v160, s37, -v16
v_exp_f32 v159, v159
v_fma_f32 v161, v161, s37, -v16
v_exp_f32 v160, v160
v_cvt_pk_bf16_f32 v143, v158, v159
v_fma_f32 v162, v162, s37, -v16
v_exp_f32 v161, v161
s_waitcnt lgkmcnt(4)
v_mfma_f32_16x16x32_bf16 v[48:51], v[24:27], v[128:131], 0
ds_read_b64_tr_b16 v[40:41], v6 offset:0
v_mfma_f32_16x16x32_bf16 v[48:51], v[28:31], v[136:139], v[48:51]
ds_read_b64_tr_b16 v[42:43], v6 offset:2048
v_fma_f32 v163, v163, s37, -v16
v_exp_f32 v162, v162
v_cvt_pk_bf16_f32 v144, v160, v161
v_fma_f32 v164, v164, s37, -v16
v_exp_f32 v163, v163
v_fma_f32 v165, v165, s37, -v16
v_exp_f32 v164, v164
v_cvt_pk_bf16_f32 v145, v162, v163
v_fma_f32 v166, v166, s37, -v16
v_exp_f32 v165, v165
s_add_u32 m0, s32, 73728
s_xor_b32 s35, s36, 33024
buffer_load_dwordx4 v13, s[20:23], s35 offen nt lds
s_waitcnt lgkmcnt(4)
v_mfma_f32_16x16x32_bf16 v[64:67], v[24:27], v[132:135], 0
ds_read_b64_tr_b16 v[44:45], v6 offset:4096
v_mfma_f32_16x16x32_bf16 v[64:67], v[28:31], v[140:143], v[64:67]
ds_read_b64_tr_b16 v[46:47], v6 offset:6144
v_fma_f32 v167, v167, s37, -v16
v_exp_f32 v166, v166
v_cvt_pk_bf16_f32 v146, v164, v165
v_fma_f32 v168, v168, s37, -v17
v_exp_f32 v167, v167
v_fma_f32 v169, v169, s37, -v17
v_exp_f32 v168, v168
v_cvt_pk_bf16_f32 v147, v166, v167
v_fma_f32 v170, v170, s37, -v17
v_exp_f32 v169, v169
s_waitcnt lgkmcnt(4)
v_mfma_f32_16x16x32_bf16 v[56:59], v[32:35], v[128:131], 0
ds_read_b64_tr_b16 v[24:25], v7 offset:0
v_mfma_f32_16x16x32_bf16 v[56:59], v[36:39], v[136:139], v[56:59]
ds_read_b64_tr_b16 v[26:27], v7 offset:2048
v_fma_f32 v171, v171, s37, -v17
v_exp_f32 v170, v170
v_cvt_pk_bf16_f32 v148, v168, v169
v_fma_f32 v172, v172, s37, -v17
v_exp_f32 v171, v171
v_mfma_f32_16x16x32_bf16 v[84:87], v[80:83], v[128:131], 0
v_mfma_f32_16x16x32_bf16 v[84:87], v[80:83], v[136:139], v[84:87]
v_fma_f32 v173, v173, s37, -v17
v_exp_f32 v172, v172
v_cvt_pk_bf16_f32 v149, v170, v171
v_fma_f32 v174, v174, s37, -v17
v_exp_f32 v173, v173
s_waitcnt lgkmcnt(4)
v_mfma_f32_16x16x32_bf16 v[72:75], v[32:35], v[132:135], 0
ds_read_b64_tr_b16 v[28:29], v7 offset:4096
v_mfma_f32_16x16x32_bf16 v[72:75], v[36:39], v[140:143], v[72:75]
ds_read_b64_tr_b16 v[30:31], v7 offset:6144
v_fma_f32 v175, v175, s37, -v17
v_exp_f32 v174, v174
v_cvt_pk_bf16_f32 v150, v172, v173
v_fma_f32 v176, v176, s37, -v16
v_exp_f32 v175, v175
v_fma_f32 v177, v177, s37, -v16
v_exp_f32 v176, v176
v_cvt_pk_bf16_f32 v151, v174, v175
v_fma_f32 v178, v178, s37, -v16
v_exp_f32 v177, v177
s_add_u32 m0, s32, 81920
s_xor_b32 s35, s36, 65792
buffer_load_dwordx4 v13, s[20:23], s35 offen nt lds
s_waitcnt lgkmcnt(4)
v_mfma_f32_16x16x32_bf16 v[52:55], v[40:43], v[128:131], 0
ds_read_b64_tr_b16 v[32:33], v4 offset:8192
v_mfma_f32_16x16x32_bf16 v[52:55], v[44:47], v[136:139], v[52:55]
ds_read_b64_tr_b16 v[34:35], v4 offset:10240
v_fma_f32 v179, v179, s37, -v16
v_exp_f32 v178, v178
v_cvt_pk_bf16_f32 v152, v176, v177
v_fma_f32 v180, v180, s37, -v16
v_exp_f32 v179, v179
v_fma_f32 v181, v181, s37, -v16
v_exp_f32 v180, v180
v_cvt_pk_bf16_f32 v153, v178, v179
v_fma_f32 v182, v182, s37, -v16
v_exp_f32 v181, v181
s_waitcnt lgkmcnt(4)
v_mfma_f32_16x16x32_bf16 v[68:71], v[40:43], v[132:135], 0
ds_read_b64_tr_b16 v[36:37], v4 offset:12288
v_mfma_f32_16x16x32_bf16 v[68:71], v[44:47], v[140:143], v[68:71]
ds_read_b64_tr_b16 v[38:39], v4 offset:14336
v_fma_f32 v183, v183, s37, -v16
v_exp_f32 v182, v182
v_cvt_pk_bf16_f32 v154, v180, v181
v_fma_f32 v184, v184, s37, -v17
v_exp_f32 v183, v183
v_mfma_f32_16x16x32_bf16 v[88:91], v[80:83], v[132:135], 0
v_mfma_f32_16x16x32_bf16 v[88:91], v[80:83], v[140:143], v[88:91]
v_fma_f32 v185, v185, s37, -v17
v_exp_f32 v184, v184
v_cvt_pk_bf16_f32 v155, v182, v183
v_fma_f32 v186, v186, s37, -v17
v_exp_f32 v185, v185
s_add_u32 m0, s32, 90112
s_xor_b32 s35, s36, 98560
buffer_load_dwordx4 v13, s[20:23], s35 offen nt lds
s_waitcnt lgkmcnt(4)
v_mfma_f32_16x16x32_bf16 v[60:63], v[24:27], v[128:131], 0
ds_read_b64_tr_b16 v[40:41], v5 offset:8192
v_mfma_f32_16x16x32_bf16 v[60:63], v[28:31], v[136:139], v[60:63]
ds_read_b64_tr_b16 v[42:43], v5 offset:10240
v_fma_f32 v187, v187, s37, -v17
v_exp_f32 v186, v186
v_cvt_pk_bf16_f32 v156, v184, v185
v_fma_f32 v188, v188, s37, -v17
v_exp_f32 v187, v187
v_fma_f32 v189, v189, s37, -v17
v_exp_f32 v188, v188
v_cvt_pk_bf16_f32 v157, v186, v187
v_fma_f32 v190, v190, s37, -v17
v_exp_f32 v189, v189
s_waitcnt lgkmcnt(4)
v_mfma_f32_16x16x32_bf16 v[76:79], v[24:27], v[132:135], 0
ds_read_b64_tr_b16 v[44:45], v5 offset:12288
v_mfma_f32_16x16x32_bf16 v[76:79], v[28:31], v[140:143], v[76:79]
ds_read_b64_tr_b16 v[46:47], v5 offset:14336
v_fma_f32 v191, v191, s37, -v17
v_exp_f32 v190, v190
v_cvt_pk_bf16_f32 v158, v188, v189
v_fma_f32 v192, v192, s37, -v16
v_exp_f32 v191, v191
v_fma_f32 v193, v193, s37, -v16
v_exp_f32 v192, v192
v_cvt_pk_bf16_f32 v159, v190, v191
v_fma_f32 v194, v194, s37, -v16
v_exp_f32 v193, v193
s_waitcnt lgkmcnt(4)
v_mfma_f32_16x16x32_bf16 v[48:51], v[32:35], v[144:147], v[48:51]
ds_read_b64_tr_b16 v[24:25], v6 offset:8192
v_mfma_f32_16x16x32_bf16 v[48:51], v[36:39], v[152:155], v[48:51]
ds_read_b64_tr_b16 v[26:27], v6 offset:10240
v_fma_f32 v195, v195, s37, -v16
v_exp_f32 v194, v194
v_cvt_pk_bf16_f32 v160, v192, v193
v_fma_f32 v196, v196, s37, -v16
v_exp_f32 v195, v195
v_fma_f32 v197, v197, s37, -v16
v_exp_f32 v196, v196
v_cvt_pk_bf16_f32 v161, v194, v195
v_fma_f32 v198, v198, s37, -v16
v_exp_f32 v197, v197
s_add_u32 m0, s32, 98304
s_xor_b32 s35, s36, 384
buffer_load_dwordx4 v13, s[20:23], s35 offen nt lds
s_waitcnt lgkmcnt(4)
v_mfma_f32_16x16x32_bf16 v[64:67], v[32:35], v[148:151], v[64:67]
ds_read_b64_tr_b16 v[28:29], v6 offset:12288
v_mfma_f32_16x16x32_bf16 v[64:67], v[36:39], v[156:159], v[64:67]
ds_read_b64_tr_b16 v[30:31], v6 offset:14336
v_fma_f32 v199, v199, s37, -v16
v_exp_f32 v198, v198
v_cvt_pk_bf16_f32 v162, v196, v197
v_fma_f32 v200, v200, s37, -v17
v_exp_f32 v199, v199
v_fma_f32 v201, v201, s37, -v17
v_exp_f32 v200, v200
v_cvt_pk_bf16_f32 v163, v198, v199
v_fma_f32 v202, v202, s37, -v17
v_exp_f32 v201, v201
s_waitcnt lgkmcnt(4)
v_mfma_f32_16x16x32_bf16 v[56:59], v[40:43], v[144:147], v[56:59]
ds_read_b64_tr_b16 v[32:33], v7 offset:8192
v_mfma_f32_16x16x32_bf16 v[56:59], v[44:47], v[152:155], v[56:59]
ds_read_b64_tr_b16 v[34:35], v7 offset:10240
v_fma_f32 v203, v203, s37, -v17
v_exp_f32 v202, v202
v_cvt_pk_bf16_f32 v164, v200, v201
v_fma_f32 v204, v204, s37, -v17
v_exp_f32 v203, v203
v_mfma_f32_16x16x32_bf16 v[84:87], v[80:83], v[144:147], v[84:87]
v_mfma_f32_16x16x32_bf16 v[84:87], v[80:83], v[152:155], v[84:87]
v_fma_f32 v205, v205, s37, -v17
v_exp_f32 v204, v204
v_cvt_pk_bf16_f32 v165, v202, v203
v_fma_f32 v206, v206, s37, -v17
v_exp_f32 v205, v205
s_waitcnt lgkmcnt(4)
v_mfma_f32_16x16x32_bf16 v[72:75], v[40:43], v[148:151], v[72:75]
ds_read_b64_tr_b16 v[36:37], v7 offset:12288
v_mfma_f32_16x16x32_bf16 v[72:75], v[44:47], v[156:159], v[72:75]
ds_read_b64_tr_b16 v[38:39], v7 offset:14336
v_fma_f32 v207, v207, s37, -v17
v_exp_f32 v206, v206
v_cvt_pk_bf16_f32 v166, v204, v205
v_fma_f32 v208, v208, s37, -v16
v_exp_f32 v207, v207
v_fma_f32 v209, v209, s37, -v16
v_exp_f32 v208, v208
v_cvt_pk_bf16_f32 v167, v206, v207
v_fma_f32 v210, v210, s37, -v16
v_exp_f32 v209, v209
s_add_u32 m0, s32, 106496
s_xor_b32 s35, s36, 33152
buffer_load_dwordx4 v13, s[20:23], s35 offen nt lds
s_waitcnt lgkmcnt(4)
s_waitcnt lgkmcnt(0)
s_barrier
v_mfma_f32_16x16x32_bf16 v[52:55], v[24:27], v[144:147], v[52:55]
ds_read_b64_tr_b16 v[40:41], v4 offset:16384
v_mfma_f32_16x16x32_bf16 v[52:55], v[28:31], v[152:155], v[52:55]
ds_read_b64_tr_b16 v[42:43], v4 offset:18432
v_fma_f32 v211, v211, s37, -v16
v_exp_f32 v210, v210
v_cvt_pk_bf16_f32 v168, v208, v209
v_fma_f32 v212, v212, s37, -v16
v_exp_f32 v211, v211
v_fma_f32 v213, v213, s37, -v16
v_exp_f32 v212, v212
v_cvt_pk_bf16_f32 v169, v210, v211
v_fma_f32 v214, v214, s37, -v16
v_exp_f32 v213, v213
v_mfma_f32_16x16x32_bf16 v[68:71], v[24:27], v[148:151], v[68:71]
ds_read_b64_tr_b16 v[44:45], v4 offset:20480
v_mfma_f32_16x16x32_bf16 v[68:71], v[28:31], v[156:159], v[68:71]
ds_read_b64_tr_b16 v[46:47], v4 offset:22528
v_fma_f32 v215, v215, s37, -v16
v_exp_f32 v214, v214
v_cvt_pk_bf16_f32 v170, v212, v213
v_fma_f32 v216, v216, s37, -v17
v_exp_f32 v215, v215
v_mfma_f32_16x16x32_bf16 v[88:91], v[80:83], v[148:151], v[88:91]
v_mfma_f32_16x16x32_bf16 v[88:91], v[80:83], v[156:159], v[88:91]
v_fma_f32 v217, v217, s37, -v17
v_exp_f32 v216, v216
v_cvt_pk_bf16_f32 v171, v214, v215
v_fma_f32 v218, v218, s37, -v17
v_exp_f32 v217, v217
s_add_u32 m0, s32, 114688
s_xor_b32 s35, s36, 65920
buffer_load_dwordx4 v13, s[20:23], s35 offen nt lds
v_mfma_f32_16x16x32_bf16 v[60:63], v[32:35], v[144:147], v[60:63]
ds_read_b64_tr_b16 v[24:25], v5 offset:16384
v_mfma_f32_16x16x32_bf16 v[60:63], v[36:39], v[152:155], v[60:63]
ds_read_b64_tr_b16 v[26:27], v5 offset:18432
v_fma_f32 v219, v219, s37, -v17
v_exp_f32 v218, v218
v_cvt_pk_bf16_f32 v172, v216, v217
v_fma_f32 v220, v220, s37, -v17
v_exp_f32 v219, v219
v_fma_f32 v221, v221, s37, -v17
v_exp_f32 v220, v220
v_cvt_pk_bf16_f32 v173, v218, v219
v_fma_f32 v222, v222, s37, -v17
v_exp_f32 v221, v221
s_waitcnt lgkmcnt(4)
v_mfma_f32_16x16x32_bf16 v[76:79], v[32:35], v[148:151], v[76:79]
ds_read_b64_tr_b16 v[28:29], v5 offset:20480
v_mfma_f32_16x16x32_bf16 v[76:79], v[36:39], v[156:159], v[76:79]
ds_read_b64_tr_b16 v[30:31], v5 offset:22528
v_fma_f32 v223, v223, s37, -v17
v_exp_f32 v222, v222
v_cvt_pk_bf16_f32 v174, v220, v221
v_fma_f32 v224, v224, s37, -v16
v_exp_f32 v223, v223
v_fma_f32 v225, v225, s37, -v16
v_exp_f32 v224, v224
v_cvt_pk_bf16_f32 v175, v222, v223
v_fma_f32 v226, v226, s37, -v16
v_exp_f32 v225, v225
s_waitcnt lgkmcnt(4)
v_mfma_f32_16x16x32_bf16 v[48:51], v[40:43], v[160:163], v[48:51]
ds_read_b64_tr_b16 v[32:33], v6 offset:16384
v_mfma_f32_16x16x32_bf16 v[48:51], v[44:47], v[168:171], v[48:51]
ds_read_b64_tr_b16 v[34:35], v6 offset:18432
v_fma_f32 v227, v227, s37, -v16
v_exp_f32 v226, v226
v_cvt_pk_bf16_f32 v176, v224, v225
v_fma_f32 v228, v228, s37, -v16
v_exp_f32 v227, v227
v_fma_f32 v229, v229, s37, -v16
v_exp_f32 v228, v228
v_cvt_pk_bf16_f32 v177, v226, v227
v_fma_f32 v230, v230, s37, -v16
v_exp_f32 v229, v229
s_add_u32 m0, s32, 122880
s_xor_b32 s35, s36, 98688
buffer_load_dwordx4 v13, s[20:23], s35 offen nt lds
s_waitcnt lgkmcnt(4)
v_mfma_f32_16x16x32_bf16 v[64:67], v[40:43], v[164:167], v[64:67]
ds_read_b64_tr_b16 v[36:37], v6 offset:20480
v_mfma_f32_16x16x32_bf16 v[64:67], v[44:47], v[172:175], v[64:67]
ds_read_b64_tr_b16 v[38:39], v6 offset:22528
v_fma_f32 v231, v231, s37, -v16
v_exp_f32 v230, v230
v_cvt_pk_bf16_f32 v178, v228, v229
v_fma_f32 v232, v232, s37, -v17
v_exp_f32 v231, v231
v_fma_f32 v233, v233, s37, -v17
v_exp_f32 v232, v232
v_cvt_pk_bf16_f32 v179, v230, v231
v_fma_f32 v234, v234, s37, -v17
v_exp_f32 v233, v233
s_waitcnt lgkmcnt(4)
v_mfma_f32_16x16x32_bf16 v[56:59], v[24:27], v[160:163], v[56:59]
ds_read_b64_tr_b16 v[40:41], v7 offset:16384
v_mfma_f32_16x16x32_bf16 v[56:59], v[28:31], v[168:171], v[56:59]
ds_read_b64_tr_b16 v[42:43], v7 offset:18432
v_fma_f32 v235, v235, s37, -v17
v_exp_f32 v234, v234
v_cvt_pk_bf16_f32 v180, v232, v233
v_fma_f32 v236, v236, s37, -v17
v_exp_f32 v235, v235
v_mfma_f32_16x16x32_bf16 v[84:87], v[80:83], v[160:163], v[84:87]
v_mfma_f32_16x16x32_bf16 v[84:87], v[80:83], v[168:171], v[84:87]
v_fma_f32 v237, v237, s37, -v17
v_exp_f32 v236, v236
v_cvt_pk_bf16_f32 v181, v234, v235
v_fma_f32 v238, v238, s37, -v17
v_exp_f32 v237, v237
s_waitcnt lgkmcnt(4)
v_mfma_f32_16x16x32_bf16 v[72:75], v[24:27], v[164:167], v[72:75]
ds_read_b64_tr_b16 v[44:45], v7 offset:20480
v_mfma_f32_16x16x32_bf16 v[72:75], v[28:31], v[172:175], v[72:75]
ds_read_b64_tr_b16 v[46:47], v7 offset:22528
v_fma_f32 v239, v239, s37, -v17
v_exp_f32 v238, v238
v_cvt_pk_bf16_f32 v182, v236, v237
v_fma_f32 v240, v240, s37, -v16
v_exp_f32 v239, v239
v_fma_f32 v241, v241, s37, -v16
v_exp_f32 v240, v240
v_cvt_pk_bf16_f32 v183, v238, v239
v_fma_f32 v242, v242, s37, -v16
v_exp_f32 v241, v241
s_add_u32 m0, s32, 131072
s_xor_b32 s35, s33, 131072
buffer_load_dwordx4 v10, s[12:15], s35 offen nt lds
s_waitcnt lgkmcnt(4)
v_mfma_f32_16x16x32_bf16 v[52:55], v[32:35], v[160:163], v[52:55]
ds_read_b64_tr_b16 v[24:25], v4 offset:24576
v_mfma_f32_16x16x32_bf16 v[52:55], v[36:39], v[168:171], v[52:55]
ds_read_b64_tr_b16 v[26:27], v4 offset:26624
v_fma_f32 v243, v243, s37, -v16
v_exp_f32 v242, v242
v_cvt_pk_bf16_f32 v184, v240, v241
v_fma_f32 v244, v244, s37, -v16
v_exp_f32 v243, v243
v_fma_f32 v245, v245, s37, -v16
v_exp_f32 v244, v244
v_cvt_pk_bf16_f32 v185, v242, v243
v_fma_f32 v246, v246, s37, -v16
v_exp_f32 v245, v245
s_waitcnt lgkmcnt(4)
v_mfma_f32_16x16x32_bf16 v[68:71], v[32:35], v[164:167], v[68:71]
ds_read_b64_tr_b16 v[28:29], v4 offset:28672
v_mfma_f32_16x16x32_bf16 v[68:71], v[36:39], v[172:175], v[68:71]
ds_read_b64_tr_b16 v[30:31], v4 offset:30720
v_fma_f32 v247, v247, s37, -v16
v_exp_f32 v246, v246
v_cvt_pk_bf16_f32 v186, v244, v245
v_fma_f32 v248, v248, s37, -v17
v_exp_f32 v247, v247
v_mfma_f32_16x16x32_bf16 v[88:91], v[80:83], v[164:167], v[88:91]
v_mfma_f32_16x16x32_bf16 v[88:91], v[80:83], v[172:175], v[88:91]
v_fma_f32 v249, v249, s37, -v17
v_exp_f32 v248, v248
v_cvt_pk_bf16_f32 v187, v246, v247
v_fma_f32 v250, v250, s37, -v17
v_exp_f32 v249, v249
s_waitcnt lgkmcnt(4)
v_mfma_f32_16x16x32_bf16 v[60:63], v[40:43], v[160:163], v[60:63]
ds_read_b64_tr_b16 v[32:33], v5 offset:24576
v_mfma_f32_16x16x32_bf16 v[60:63], v[44:47], v[168:171], v[60:63]
ds_read_b64_tr_b16 v[34:35], v5 offset:26624
v_fma_f32 v251, v251, s37, -v17
v_exp_f32 v250, v250
v_cvt_pk_bf16_f32 v188, v248, v249
v_fma_f32 v252, v252, s37, -v17
v_exp_f32 v251, v251
v_fma_f32 v253, v253, s37, -v17
v_exp_f32 v252, v252
v_cvt_pk_bf16_f32 v189, v250, v251
v_fma_f32 v254, v254, s37, -v17
v_exp_f32 v253, v253
s_add_u32 m0, s32, 139264
s_xor_b32 s35, s33, 131072
buffer_load_dwordx4 v11, s[12:15], s35 offen nt lds
s_waitcnt lgkmcnt(4)
v_mfma_f32_16x16x32_bf16 v[76:79], v[40:43], v[164:167], v[76:79]
ds_read_b64_tr_b16 v[36:37], v5 offset:28672
v_mfma_f32_16x16x32_bf16 v[76:79], v[44:47], v[172:175], v[76:79]
ds_read_b64_tr_b16 v[38:39], v5 offset:30720
v_fma_f32 v255, v255, s37, -v17
v_exp_f32 v254, v254
v_cvt_pk_bf16_f32 v190, v252, v253
v_exp_f32 v255, v255
s_nop 0
v_cvt_pk_bf16_f32 v191, v254, v255
s_nop 0
s_nop 0
s_waitcnt lgkmcnt(4)
v_mfma_f32_16x16x32_bf16 v[48:51], v[24:27], v[176:179], v[48:51]
ds_read_b64_tr_b16 v[40:41], v6 offset:24576
v_mfma_f32_16x16x32_bf16 v[48:51], v[28:31], v[184:187], v[48:51]
ds_read_b64_tr_b16 v[42:43], v6 offset:26624
s_waitcnt lgkmcnt(4)
v_mfma_f32_16x16x32_bf16 v[64:67], v[24:27], v[180:183], v[64:67]
ds_read_b64_tr_b16 v[44:45], v6 offset:28672
v_mfma_f32_16x16x32_bf16 v[64:67], v[28:31], v[188:191], v[64:67]
ds_read_b64_tr_b16 v[46:47], v6 offset:30720
s_waitcnt lgkmcnt(4)
v_mfma_f32_16x16x32_bf16 v[56:59], v[32:35], v[176:179], v[56:59]
ds_read_b64_tr_b16 v[24:25], v7 offset:24576
v_mfma_f32_16x16x32_bf16 v[56:59], v[36:39], v[184:187], v[56:59]
ds_read_b64_tr_b16 v[26:27], v7 offset:26624
v_mfma_f32_16x16x32_bf16 v[84:87], v[80:83], v[176:179], v[84:87]
v_mfma_f32_16x16x32_bf16 v[84:87], v[80:83], v[184:187], v[84:87]
s_waitcnt lgkmcnt(4)
v_mfma_f32_16x16x32_bf16 v[72:75], v[32:35], v[180:183], v[72:75]
ds_read_b64_tr_b16 v[28:29], v7 offset:28672
v_mfma_f32_16x16x32_bf16 v[72:75], v[36:39], v[188:191], v[72:75]
ds_read_b64_tr_b16 v[30:31], v7 offset:30720
s_add_u32 m0, s32, 147456
s_xor_b32 s35, s33, 139264
buffer_load_dwordx4 v10, s[12:15], s35 offen nt lds
s_waitcnt lgkmcnt(4)
s_waitcnt lgkmcnt(0)
s_waitcnt vmcnt(13)
s_barrier
v_mfma_f32_16x16x32_bf16 v[52:55], v[40:43], v[176:179], v[52:55]
ds_read_b64_tr_b16 v[32:33], v4 offset:32768
v_mfma_f32_16x16x32_bf16 v[52:55], v[44:47], v[184:187], v[52:55]
ds_read_b64_tr_b16 v[34:35], v4 offset:34816
v_mfma_f32_16x16x32_bf16 v[68:71], v[40:43], v[180:183], v[68:71]
ds_read_b64_tr_b16 v[36:37], v4 offset:36864
v_mfma_f32_16x16x32_bf16 v[68:71], v[44:47], v[188:191], v[68:71]
ds_read_b64_tr_b16 v[38:39], v4 offset:38912
v_mfma_f32_16x16x32_bf16 v[88:91], v[80:83], v[180:183], v[88:91]
v_mfma_f32_16x16x32_bf16 v[88:91], v[80:83], v[188:191], v[88:91]
v_mfma_f32_16x16x32_bf16 v[60:63], v[24:27], v[176:179], v[60:63]
ds_read_b64_tr_b16 v[40:41], v4 offset:40960
v_mfma_f32_16x16x32_bf16 v[60:63], v[28:31], v[184:187], v[60:63]
ds_read_b64_tr_b16 v[42:43], v4 offset:43008
s_waitcnt lgkmcnt(4)
v_mfma_f32_16x16x32_bf16 v[76:79], v[24:27], v[180:183], v[76:79]
ds_read_b64_tr_b16 v[44:45], v4 offset:45056
v_mfma_f32_16x16x32_bf16 v[76:79], v[28:31], v[188:191], v[76:79]
ds_read_b64_tr_b16 v[46:47], v4 offset:47104
s_waitcnt lgkmcnt(0)
v_mfma_f32_16x16x32_bf16 v[192:195], v[32:35], v[128:131], 0
v_mfma_f32_16x16x32_bf16 v[192:195], v[36:39], v[136:139], v[192:195]
v_mfma_f32_16x16x32_bf16 v[192:195], v[40:43], v[144:147], v[192:195]
v_mfma_f32_16x16x32_bf16 v[192:195], v[44:47], v[152:155], v[192:195]
s_add_u32 m0, s32, 155648
s_xor_b32 s35, s33, 139264
buffer_load_dwordx4 v11, s[12:15], s35 offen nt lds
v_mfma_f32_16x16x32_bf16 v[208:211], v[32:35], v[132:135], 0
v_mfma_f32_16x16x32_bf16 v[208:211], v[36:39], v[140:143], v[208:211]
v_mfma_f32_16x16x32_bf16 v[208:211], v[40:43], v[148:151], v[208:211]
v_mfma_f32_16x16x32_bf16 v[208:211], v[44:47], v[156:159], v[208:211]
v_rcp_f32 v18, v84
v_rcp_f32 v20, v88
v_mul_f32 v48, v18, v48
v_mul_f32 v49, v18, v49
ds_read_b64_tr_b16 v[24:25], v6 offset:32768
ds_read_b64_tr_b16 v[26:27], v6 offset:34816
ds_read_b64_tr_b16 v[28:29], v6 offset:36864
ds_read_b64_tr_b16 v[30:31], v6 offset:38912
s_waitcnt lgkmcnt(0)
ds_read_b64_tr_b16 v[32:33], v6 offset:40960
ds_read_b64_tr_b16 v[34:35], v6 offset:43008
s_waitcnt lgkmcnt(0)
ds_read_b64_tr_b16 v[36:37], v6 offset:45056
ds_read_b64_tr_b16 v[38:39], v6 offset:47104
s_waitcnt lgkmcnt(0)
v_mfma_f32_16x16x32_bf16 v[196:199], v[24:27], v[128:131], 0
v_mfma_f32_16x16x32_bf16 v[196:199], v[28:31], v[136:139], v[196:199]
v_mfma_f32_16x16x32_bf16 v[196:199], v[32:35], v[144:147], v[196:199]
v_mfma_f32_16x16x32_bf16 v[196:199], v[36:39], v[152:155], v[196:199]
v_mul_f32 v50, v18, v50
v_mul_f32 v51, v18, v51
v_mul_f32 v52, v18, v52
v_mul_f32 v53, v18, v53
v_mul_f32 v54, v18, v54
v_mul_f32 v55, v18, v55
v_cvt_pk_bf16_f32 v48, v48, v49
v_cvt_pk_bf16_f32 v49, v50, v51
v_mfma_f32_16x16x32_bf16 v[212:215], v[24:27], v[132:135], 0
v_mfma_f32_16x16x32_bf16 v[212:215], v[28:31], v[140:143], v[212:215]
v_mfma_f32_16x16x32_bf16 v[212:215], v[32:35], v[148:151], v[212:215]
v_mfma_f32_16x16x32_bf16 v[212:215], v[36:39], v[156:159], v[212:215]
v_cvt_pk_bf16_f32 v50, v52, v53
v_cvt_pk_bf16_f32 v51, v54, v55
v_mul_f32 v56, v18, v56
v_mul_f32 v57, v18, v57
v_mul_f32 v58, v18, v58
v_permlane16_swap_b32 v48, v50
s_add_u32 m0, s32, 0
s_xor_b32 s35, s34, 131072
buffer_load_dwordx4 v12, s[16:19], s35 offen nt lds
ds_read_b64_tr_b16 v[40:41], v5 offset:32768
ds_read_b64_tr_b16 v[42:43], v5 offset:34816
ds_read_b64_tr_b16 v[44:45], v5 offset:36864
ds_read_b64_tr_b16 v[46:47], v5 offset:38912
s_waitcnt lgkmcnt(0)
ds_read_b64_tr_b16 v[24:25], v5 offset:40960
ds_read_b64_tr_b16 v[26:27], v5 offset:43008
s_waitcnt lgkmcnt(0)
ds_read_b64_tr_b16 v[28:29], v5 offset:45056
ds_read_b64_tr_b16 v[30:31], v5 offset:47104
s_waitcnt lgkmcnt(0)
v_mfma_f32_16x16x32_bf16 v[200:203], v[40:43], v[128:131], 0
v_mfma_f32_16x16x32_bf16 v[200:203], v[44:47], v[136:139], v[200:203]
v_mfma_f32_16x16x32_bf16 v[200:203], v[24:27], v[144:147], v[200:203]
v_mfma_f32_16x16x32_bf16 v[200:203], v[28:31], v[152:155], v[200:203]
v_mul_f32 v59, v18, v59
v_mul_f32 v60, v18, v60
v_mul_f32 v61, v18, v61
v_mul_f32 v62, v18, v62
v_mul_f32 v63, v18, v63
v_permlane16_swap_b32 v49, v51
v_mfma_f32_16x16x32_bf16 v[216:219], v[40:43], v[132:135], 0
v_mfma_f32_16x16x32_bf16 v[216:219], v[44:47], v[140:143], v[216:219]
v_mfma_f32_16x16x32_bf16 v[216:219], v[24:27], v[148:151], v[216:219]
v_mfma_f32_16x16x32_bf16 v[216:219], v[28:31], v[156:159], v[216:219]
v_cvt_pk_bf16_f32 v52, v56, v57
v_cvt_pk_bf16_f32 v53, v58, v59
v_cvt_pk_bf16_f32 v54, v60, v61
v_cvt_pk_bf16_f32 v55, v62, v63
v_mul_f32 v64, v20, v64
v_mul_f32 v65, v20, v65
s_add_u32 m0, s32, 8192
s_xor_b32 s35, s34, 163840
buffer_load_dwordx4 v12, s[16:19], s35 offen nt lds
ds_read_b64_tr_b16 v[32:33], v7 offset:32768
ds_read_b64_tr_b16 v[34:35], v7 offset:34816
ds_read_b64_tr_b16 v[36:37], v7 offset:36864
ds_read_b64_tr_b16 v[38:39], v7 offset:38912
s_waitcnt lgkmcnt(0)
ds_read_b64_tr_b16 v[40:41], v7 offset:40960
ds_read_b64_tr_b16 v[42:43], v7 offset:43008
s_waitcnt lgkmcnt(0)
ds_read_b64_tr_b16 v[44:45], v7 offset:45056
ds_read_b64_tr_b16 v[46:47], v7 offset:47104
s_waitcnt lgkmcnt(0)
s_waitcnt vmcnt(14)
s_barrier
v_mfma_f32_16x16x32_bf16 v[204:207], v[32:35], v[128:131], 0
v_mfma_f32_16x16x32_bf16 v[204:207], v[36:39], v[136:139], v[204:207]
v_mfma_f32_16x16x32_bf16 v[204:207], v[40:43], v[144:147], v[204:207]
v_mfma_f32_16x16x32_bf16 v[204:207], v[44:47], v[152:155], v[204:207]
v_mul_f32 v66, v20, v66
v_permlane16_swap_b32 v52, v54
v_mul_f32 v67, v20, v67
v_permlane16_swap_b32 v53, v55
v_mfma_f32_16x16x32_bf16 v[220:223], v[32:35], v[132:135], 0
v_mfma_f32_16x16x32_bf16 v[220:223], v[36:39], v[140:143], v[220:223]
v_mfma_f32_16x16x32_bf16 v[220:223], v[40:43], v[148:151], v[220:223]
v_mfma_f32_16x16x32_bf16 v[220:223], v[44:47], v[156:159], v[220:223]
v_mul_f32 v68, v20, v68
s_mov_b64 vcc, s[62:63]
v_cndmask_b32_dpp v80, v52, v48, vcc quad_perm:[1,0,3,2] row_mask:0xf bank_mask:0xf
v_mul_f32 v69, v20, v69
v_cndmask_b32_dpp v82, v54, v50, vcc quad_perm:[1,0,3,2] row_mask:0xf bank_mask:0xf
v_mul_f32 v70, v20, v70
v_cndmask_b32_dpp v81, v53, v49, vcc quad_perm:[1,0,3,2] row_mask:0xf bank_mask:0xf
v_mul_f32 v71, v20, v71
s_add_u32 m0, s32, 16384
s_xor_b32 s35, s34, 196608
buffer_load_dwordx4 v12, s[16:19], s35 offen nt lds
ds_read_b64_tr_b16 v[24:25], v4 offset:49152
ds_read_b64_tr_b16 v[26:27], v4 offset:51200
ds_read_b64_tr_b16 v[28:29], v4 offset:53248
ds_read_b64_tr_b16 v[30:31], v4 offset:55296
s_waitcnt lgkmcnt(0)
ds_read_b64_tr_b16 v[32:33], v4 offset:57344
ds_read_b64_tr_b16 v[34:35], v4 offset:59392
s_waitcnt lgkmcnt(0)
ds_read_b64_tr_b16 v[36:37], v4 offset:61440
ds_read_b64_tr_b16 v[38:39], v4 offset:63488
s_waitcnt lgkmcnt(0)
v_mfma_f32_16x16x32_bf16 v[192:195], v[24:27], v[160:163], v[192:195]
v_mfma_f32_16x16x32_bf16 v[192:195], v[28:31], v[168:171], v[192:195]
v_mfma_f32_16x16x32_bf16 v[192:195], v[32:35], v[176:179], v[192:195]
v_mfma_f32_16x16x32_bf16 v[192:195], v[36:39], v[184:187], v[192:195]
v_cndmask_b32_dpp v83, v55, v51, vcc quad_perm:[1,0,3,2] row_mask:0xf bank_mask:0xf
v_cvt_pk_bf16_f32 v64, v64, v65
v_cvt_pk_bf16_f32 v65, v66, v67
v_cvt_pk_bf16_f32 v66, v68, v69
v_cvt_pk_bf16_f32 v67, v70, v71
v_mul_f32 v72, v20, v72
s_not_b64 vcc, vcc
v_cndmask_b32_dpp v84, v48, v52, vcc quad_perm:[1,0,3,2] row_mask:0xf bank_mask:0xf
v_mfma_f32_16x16x32_bf16 v[208:211], v[24:27], v[164:167], v[208:211]
v_mfma_f32_16x16x32_bf16 v[208:211], v[28:31], v[172:175], v[208:211]
v_mfma_f32_16x16x32_bf16 v[208:211], v[32:35], v[180:183], v[208:211]
v_mfma_f32_16x16x32_bf16 v[208:211], v[36:39], v[188:191], v[208:211]
v_mul_f32 v73, v20, v73
v_cndmask_b32_dpp v86, v50, v54, vcc quad_perm:[1,0,3,2] row_mask:0xf bank_mask:0xf
v_mul_f32 v74, v20, v74
v_cndmask_b32_dpp v85, v49, v53, vcc quad_perm:[1,0,3,2] row_mask:0xf bank_mask:0xf
v_mul_f32 v75, v20, v75
v_cndmask_b32_dpp v87, v51, v55, vcc quad_perm:[1,0,3,2] row_mask:0xf bank_mask:0xf
v_mul_f32 v76, v20, v76
ds_read_b64_tr_b16 v[40:41], v6 offset:49152
ds_read_b64_tr_b16 v[42:43], v6 offset:51200
ds_read_b64_tr_b16 v[44:45], v6 offset:53248
ds_read_b64_tr_b16 v[46:47], v6 offset:55296
s_waitcnt lgkmcnt(0)
ds_read_b64_tr_b16 v[24:25], v6 offset:57344
ds_read_b64_tr_b16 v[26:27], v6 offset:59392
s_waitcnt lgkmcnt(0)
ds_read_b64_tr_b16 v[28:29], v6 offset:61440
ds_read_b64_tr_b16 v[30:31], v6 offset:63488
s_waitcnt lgkmcnt(0)
v_mfma_f32_16x16x32_bf16 v[196:199], v[40:43], v[160:163], v[196:199]
v_mfma_f32_16x16x32_bf16 v[196:199], v[44:47], v[168:171], v[196:199]
v_mfma_f32_16x16x32_bf16 v[196:199], v[24:27], v[176:179], v[196:199]
v_mfma_f32_16x16x32_bf16 v[196:199], v[28:31], v[184:187], v[196:199]
v_mul_f32 v77, v20, v77
v_permlane16_swap_b32 v64, v66
v_mul_f32 v78, v20, v78
v_permlane16_swap_b32 v65, v67
buffer_store_dwordx4 v[80:83], v14, s[24:27], s72 offen offset:0 sc1
v_mfma_f32_16x16x32_bf16 v[212:215], v[40:43], v[164:167], v[212:215]
v_mfma_f32_16x16x32_bf16 v[212:215], v[44:47], v[172:175], v[212:215]
v_mfma_f32_16x16x32_bf16 v[212:215], v[24:27], v[180:183], v[212:215]
v_mfma_f32_16x16x32_bf16 v[212:215], v[28:31], v[188:191], v[212:215]
v_mul_f32 v79, v20, v79
v_cvt_pk_bf16_f32 v68, v72, v73
v_cvt_pk_bf16_f32 v69, v74, v75
v_cvt_pk_bf16_f32 v70, v76, v77
v_cvt_pk_bf16_f32 v71, v78, v79
s_nop 0
ds_read_b64_tr_b16 v[32:33], v5 offset:49152
ds_read_b64_tr_b16 v[34:35], v5 offset:51200
ds_read_b64_tr_b16 v[36:37], v5 offset:53248
ds_read_b64_tr_b16 v[38:39], v5 offset:55296
s_waitcnt lgkmcnt(0)
ds_read_b64_tr_b16 v[40:41], v5 offset:57344
ds_read_b64_tr_b16 v[42:43], v5 offset:59392
s_waitcnt lgkmcnt(0)
ds_read_b64_tr_b16 v[44:45], v5 offset:61440
ds_read_b64_tr_b16 v[46:47], v5 offset:63488
s_waitcnt lgkmcnt(0)
v_mfma_f32_16x16x32_bf16 v[200:203], v[32:35], v[160:163], v[200:203]
v_mfma_f32_16x16x32_bf16 v[200:203], v[36:39], v[168:171], v[200:203]
v_mfma_f32_16x16x32_bf16 v[200:203], v[40:43], v[176:179], v[200:203]
v_mfma_f32_16x16x32_bf16 v[200:203], v[44:47], v[184:187], v[200:203]
v_permlane16_swap_b32 v68, v70
v_permlane16_swap_b32 v69, v71
s_add_u32 m0, s32, 24576
s_xor_b32 s35, s34, 229376
buffer_load_dwordx4 v12, s[16:19], s35 offen nt lds
v_mfma_f32_16x16x32_bf16 v[216:219], v[32:35], v[164:167], v[216:219]
v_mfma_f32_16x16x32_bf16 v[216:219], v[36:39], v[172:175], v[216:219]
v_mfma_f32_16x16x32_bf16 v[216:219], v[40:43], v[180:183], v[216:219]
v_mfma_f32_16x16x32_bf16 v[216:219], v[44:47], v[188:191], v[216:219]
s_not_b64 vcc, vcc
s_nop 0
v_cndmask_b32_dpp v88, v68, v64, vcc quad_perm:[1,0,3,2] row_mask:0xf bank_mask:0xf
v_cndmask_b32_dpp v90, v70, v66, vcc quad_perm:[1,0,3,2] row_mask:0xf bank_mask:0xf
v_cndmask_b32_dpp v89, v69, v65, vcc quad_perm:[1,0,3,2] row_mask:0xf bank_mask:0xf
v_cndmask_b32_dpp v91, v71, v67, vcc quad_perm:[1,0,3,2] row_mask:0xf bank_mask:0xf
s_not_b64 vcc, vcc
v_cndmask_b32_dpp v92, v64, v68, vcc quad_perm:[1,0,3,2] row_mask:0xf bank_mask:0xf
ds_read_b64_tr_b16 v[24:25], v7 offset:49152
ds_read_b64_tr_b16 v[26:27], v7 offset:51200
ds_read_b64_tr_b16 v[28:29], v7 offset:53248
ds_read_b64_tr_b16 v[30:31], v7 offset:55296
s_waitcnt lgkmcnt(0)
ds_read_b64_tr_b16 v[32:33], v7 offset:57344
ds_read_b64_tr_b16 v[34:35], v7 offset:59392
s_waitcnt lgkmcnt(0)
ds_read_b64_tr_b16 v[36:37], v7 offset:61440
ds_read_b64_tr_b16 v[38:39], v7 offset:63488
s_waitcnt lgkmcnt(0)
s_waitcnt vmcnt(15)
s_barrier
v_mfma_f32_16x16x32_bf16 v[204:207], v[24:27], v[160:163], v[204:207]
v_mfma_f32_16x16x32_bf16 v[204:207], v[28:31], v[168:171], v[204:207]
v_mfma_f32_16x16x32_bf16 v[204:207], v[32:35], v[176:179], v[204:207]
v_mfma_f32_16x16x32_bf16 v[204:207], v[36:39], v[184:187], v[204:207]
v_cndmask_b32_dpp v94, v66, v70, vcc quad_perm:[1,0,3,2] row_mask:0xf bank_mask:0xf
v_cndmask_b32_dpp v93, v65, v69, vcc quad_perm:[1,0,3,2] row_mask:0xf bank_mask:0xf
v_cndmask_b32_dpp v95, v67, v71, vcc quad_perm:[1,0,3,2] row_mask:0xf bank_mask:0xf
buffer_store_dwordx4 v[84:87], v14, s[24:27], s72 offen offset:512 sc1
v_mfma_f32_16x16x32_bf16 v[220:223], v[24:27], v[164:167], v[220:223]
v_mfma_f32_16x16x32_bf16 v[220:223], v[28:31], v[172:175], v[220:223]
v_mfma_f32_16x16x32_bf16 v[220:223], v[32:35], v[180:183], v[220:223]
v_mfma_f32_16x16x32_bf16 v[220:223], v[36:39], v[188:191], v[220:223]
s_waitcnt vmcnt(8)
ds_read_b128 v[48:51], v8 offset:0
ds_read_b128 v[52:55], v9 offset:0
s_waitcnt vmcnt(6)
ds_read_b128 v[56:59], v8 offset:16384
ds_read_b128 v[60:63], v9 offset:16384
v_xor_b32 v4, 0x10000, v4
v_xor_b32 v5, 0x10000, v5
v_xor_b32 v6, 0x10000, v6
v_xor_b32 v7, 0x10000, v7
ds_read_b64_tr_b16 v[40:41], v4 offset:0
ds_read_b64_tr_b16 v[42:43], v4 offset:2048
ds_read_b64_tr_b16 v[44:45], v4 offset:4096
ds_read_b64_tr_b16 v[46:47], v4 offset:6144
s_waitcnt lgkmcnt(0)
ds_read_b64_tr_b16 v[24:25], v4 offset:8192
ds_read_b64_tr_b16 v[26:27], v4 offset:10240
s_waitcnt lgkmcnt(0)
ds_read_b64_tr_b16 v[28:29], v4 offset:12288
ds_read_b64_tr_b16 v[30:31], v4 offset:14336
s_waitcnt lgkmcnt(0)
v_mfma_f32_16x16x32_bf16 v[224:227], v[40:43], v[128:131], 0
v_mfma_f32_16x16x32_bf16 v[224:227], v[44:47], v[136:139], v[224:227]
v_mfma_f32_16x16x32_bf16 v[224:227], v[24:27], v[144:147], v[224:227]
v_mfma_f32_16x16x32_bf16 v[224:227], v[28:31], v[152:155], v[224:227]
v_mfma_f32_16x16x32_bf16 v[240:243], v[40:43], v[132:135], 0
v_mfma_f32_16x16x32_bf16 v[240:243], v[44:47], v[140:143], v[240:243]
v_mfma_f32_16x16x32_bf16 v[240:243], v[24:27], v[148:151], v[240:243]
v_mfma_f32_16x16x32_bf16 v[240:243], v[28:31], v[156:159], v[240:243]
v_mul_f32 v192, v18, v192
v_mul_f32 v193, v18, v193
v_mul_f32 v194, v18, v194
v_mul_f32 v195, v18, v195
s_add_u32 m0, s32, 32768
s_xor_b32 s35, s34, 131200
buffer_load_dwordx4 v12, s[16:19], s35 offen nt lds
ds_read_b64_tr_b16 v[32:33], v6 offset:0
ds_read_b64_tr_b16 v[34:35], v6 offset:2048
ds_read_b64_tr_b16 v[36:37], v6 offset:4096
ds_read_b64_tr_b16 v[38:39], v6 offset:6144
s_waitcnt lgkmcnt(0)
ds_read_b64_tr_b16 v[40:41], v6 offset:8192
ds_read_b64_tr_b16 v[42:43], v6 offset:10240
s_waitcnt lgkmcnt(0)
ds_read_b64_tr_b16 v[44:45], v6 offset:12288
ds_read_b64_tr_b16 v[46:47], v6 offset:14336
s_waitcnt lgkmcnt(0)
v_mfma_f32_16x16x32_bf16 v[228:231], v[32:35], v[128:131], 0
v_mfma_f32_16x16x32_bf16 v[228:231], v[36:39], v[136:139], v[228:231]
v_mfma_f32_16x16x32_bf16 v[228:231], v[40:43], v[144:147], v[228:231]
v_mfma_f32_16x16x32_bf16 v[228:231], v[44:47], v[152:155], v[228:231]
v_mul_f32 v196, v18, v196
v_mul_f32 v197, v18, v197
v_mul_f32 v198, v18, v198
v_mul_f32 v199, v18, v199
v_cvt_pk_bf16_f32 v192, v192, v193
v_cvt_pk_bf16_f32 v193, v194, v195
v_cvt_pk_bf16_f32 v194, v196, v197
v_cvt_pk_bf16_f32 v195, v198, v199
v_mfma_f32_16x16x32_bf16 v[244:247], v[32:35], v[132:135], 0
v_mfma_f32_16x16x32_bf16 v[244:247], v[36:39], v[140:143], v[244:247]
v_mfma_f32_16x16x32_bf16 v[244:247], v[40:43], v[148:151], v[244:247]
v_mfma_f32_16x16x32_bf16 v[244:247], v[44:47], v[156:159], v[244:247]
v_mul_f32 v200, v18, v200
v_mul_f32 v201, v18, v201
v_mul_f32 v202, v18, v202
v_permlane16_swap_b32 v192, v194
buffer_store_dwordx4 v[88:91], v14, s[24:27], s73 offen offset:0 sc1
ds_read_b64_tr_b16 v[24:25], v5 offset:0
ds_read_b64_tr_b16 v[26:27], v5 offset:2048
ds_read_b64_tr_b16 v[28:29], v5 offset:4096
ds_read_b64_tr_b16 v[30:31], v5 offset:6144
s_waitcnt lgkmcnt(0)
ds_read_b64_tr_b16 v[32:33], v5 offset:8192
ds_read_b64_tr_b16 v[34:35], v5 offset:10240
s_waitcnt lgkmcnt(0)
ds_read_b64_tr_b16 v[36:37], v5 offset:12288
ds_read_b64_tr_b16 v[38:39], v5 offset:14336
s_waitcnt lgkmcnt(0)
v_mfma_f32_16x16x32_bf16 v[232:235], v[24:27], v[128:131], 0
v_mfma_f32_16x16x32_bf16 v[232:235], v[28:31], v[136:139], v[232:235]
v_mfma_f32_16x16x32_bf16 v[232:235], v[32:35], v[144:147], v[232:235]
v_mfma_f32_16x16x32_bf16 v[232:235], v[36:39], v[152:155], v[232:235]
v_mul_f32 v203, v18, v203
v_mul_f32 v204, v18, v204
v_mul_f32 v205, v18, v205
v_mul_f32 v206, v18, v206
v_mul_f32 v207, v18, v207
v_permlane16_swap_b32 v193, v195
v_mfma_f32_16x16x32_bf16 v[248:251], v[24:27], v[132:135], 0
v_mfma_f32_16x16x32_bf16 v[248:251], v[28:31], v[140:143], v[248:251]
v_mfma_f32_16x16x32_bf16 v[248:251], v[32:35], v[148:151], v[248:251]
v_mfma_f32_16x16x32_bf16 v[248:251], v[36:39], v[156:159], v[248:251]
v_cvt_pk_bf16_f32 v196, v200, v201
v_cvt_pk_bf16_f32 v197, v202, v203
v_cvt_pk_bf16_f32 v198, v204, v205
v_cvt_pk_bf16_f32 v199, v206, v207
v_mul_f32 v208, v20, v208
v_mul_f32 v209, v20, v209
s_add_u32 m0, s32, 40960
s_xor_b32 s35, s34, 163968
buffer_load_dwordx4 v12, s[16:19], s35 offen nt lds
ds_read_b64_tr_b16 v[40:41], v7 offset:0
ds_read_b64_tr_b16 v[42:43], v7 offset:2048
ds_read_b64_tr_b16 v[44:45], v7 offset:4096
ds_read_b64_tr_b16 v[46:47], v7 offset:6144
s_waitcnt lgkmcnt(0)
ds_read_b64_tr_b16 v[24:25], v7 offset:8192
ds_read_b64_tr_b16 v[26:27], v7 offset:10240
s_waitcnt lgkmcnt(0)
ds_read_b64_tr_b16 v[28:29], v7 offset:12288
ds_read_b64_tr_b16 v[30:31], v7 offset:14336
s_waitcnt lgkmcnt(0)
s_barrier
v_mfma_f32_16x16x32_bf16 v[236:239], v[40:43], v[128:131], 0
v_mfma_f32_16x16x32_bf16 v[236:239], v[44:47], v[136:139], v[236:239]
v_mfma_f32_16x16x32_bf16 v[236:239], v[24:27], v[144:147], v[236:239]
v_mfma_f32_16x16x32_bf16 v[236:239], v[28:31], v[152:155], v[236:239]
v_mul_f32 v210, v20, v210
v_permlane16_swap_b32 v196, v198
v_mul_f32 v211, v20, v211
v_permlane16_swap_b32 v197, v199
v_mfma_f32_16x16x32_bf16 v[252:255], v[40:43], v[132:135], 0
v_mfma_f32_16x16x32_bf16 v[252:255], v[44:47], v[140:143], v[252:255]
v_mfma_f32_16x16x32_bf16 v[252:255], v[24:27], v[148:151], v[252:255]
v_mfma_f32_16x16x32_bf16 v[252:255], v[28:31], v[156:159], v[252:255]
v_mul_f32 v212, v20, v212
s_mov_b64 vcc, s[62:63]
v_cndmask_b32_dpp v64, v196, v192, vcc quad_perm:[1,0,3,2] row_mask:0xf bank_mask:0xf
v_mul_f32 v213, v20, v213
v_cndmask_b32_dpp v66, v198, v194, vcc quad_perm:[1,0,3,2] row_mask:0xf bank_mask:0xf
v_mul_f32 v214, v20, v214
v_cndmask_b32_dpp v65, v197, v193, vcc quad_perm:[1,0,3,2] row_mask:0xf bank_mask:0xf
v_mul_f32 v215, v20, v215
buffer_store_dwordx4 v[92:95], v14, s[24:27], s73 offen offset:512 sc1
ds_read_b64_tr_b16 v[32:33], v4 offset:16384
ds_read_b64_tr_b16 v[34:35], v4 offset:18432
ds_read_b64_tr_b16 v[36:37], v4 offset:20480
ds_read_b64_tr_b16 v[38:39], v4 offset:22528
s_waitcnt lgkmcnt(0)
ds_read_b64_tr_b16 v[40:41], v4 offset:24576
ds_read_b64_tr_b16 v[42:43], v4 offset:26624
s_waitcnt lgkmcnt(0)
ds_read_b64_tr_b16 v[44:45], v4 offset:28672
ds_read_b64_tr_b16 v[46:47], v4 offset:30720
s_waitcnt lgkmcnt(0)
v_mfma_f32_16x16x32_bf16 v[224:227], v[32:35], v[160:163], v[224:227]
v_mfma_f32_16x16x32_bf16 v[224:227], v[36:39], v[168:171], v[224:227]
v_mfma_f32_16x16x32_bf16 v[224:227], v[40:43], v[176:179], v[224:227]
v_mfma_f32_16x16x32_bf16 v[224:227], v[44:47], v[184:187], v[224:227]
v_cndmask_b32_dpp v67, v199, v195, vcc quad_perm:[1,0,3,2] row_mask:0xf bank_mask:0xf
v_cvt_pk_bf16_f32 v208, v208, v209
v_cvt_pk_bf16_f32 v209, v210, v211
v_cvt_pk_bf16_f32 v210, v212, v213
v_cvt_pk_bf16_f32 v211, v214, v215
v_mul_f32 v216, v20, v216
s_not_b64 vcc, vcc
v_cndmask_b32_dpp v68, v192, v196, vcc quad_perm:[1,0,3,2] row_mask:0xf bank_mask:0xf
v_mfma_f32_16x16x32_bf16 v[240:243], v[32:35], v[164:167], v[240:243]
v_mfma_f32_16x16x32_bf16 v[240:243], v[36:39], v[172:175], v[240:243]
v_mfma_f32_16x16x32_bf16 v[240:243], v[40:43], v[180:183], v[240:243]
v_mfma_f32_16x16x32_bf16 v[240:243], v[44:47], v[188:191], v[240:243]
v_mul_f32 v217, v20, v217
v_cndmask_b32_dpp v70, v194, v198, vcc quad_perm:[1,0,3,2] row_mask:0xf bank_mask:0xf
v_mul_f32 v218, v20, v218
v_cndmask_b32_dpp v69, v193, v197, vcc quad_perm:[1,0,3,2] row_mask:0xf bank_mask:0xf
v_mul_f32 v219, v20, v219
v_cndmask_b32_dpp v71, v195, v199, vcc quad_perm:[1,0,3,2] row_mask:0xf bank_mask:0xf
v_mul_f32 v220, v20, v220
ds_read_b64_tr_b16 v[24:25], v6 offset:16384
ds_read_b64_tr_b16 v[26:27], v6 offset:18432
ds_read_b64_tr_b16 v[28:29], v6 offset:20480
ds_read_b64_tr_b16 v[30:31], v6 offset:22528
s_waitcnt lgkmcnt(0)
ds_read_b64_tr_b16 v[32:33], v6 offset:24576
ds_read_b64_tr_b16 v[34:35], v6 offset:26624
s_waitcnt lgkmcnt(0)
ds_read_b64_tr_b16 v[36:37], v6 offset:28672
ds_read_b64_tr_b16 v[38:39], v6 offset:30720
s_waitcnt lgkmcnt(0)
v_mfma_f32_16x16x32_bf16 v[228:231], v[24:27], v[160:163], v[228:231]
v_mfma_f32_16x16x32_bf16 v[228:231], v[28:31], v[168:171], v[228:231]
v_mfma_f32_16x16x32_bf16 v[228:231], v[32:35], v[176:179], v[228:231]
v_mfma_f32_16x16x32_bf16 v[228:231], v[36:39], v[184:187], v[228:231]
v_mul_f32 v221, v20, v221
v_permlane16_swap_b32 v208, v210
v_mul_f32 v222, v20, v222
v_permlane16_swap_b32 v209, v211
s_add_u32 m0, s32, 131072
s_xor_b32 s35, s33, 131200
buffer_load_dwordx4 v10, s[12:15], s35 offen nt lds
v_mfma_f32_16x16x32_bf16 v[244:247], v[24:27], v[164:167], v[244:247]
v_mfma_f32_16x16x32_bf16 v[244:247], v[28:31], v[172:175], v[244:247]
v_mfma_f32_16x16x32_bf16 v[244:247], v[32:35], v[180:183], v[244:247]
v_mfma_f32_16x16x32_bf16 v[244:247], v[36:39], v[188:191], v[244:247]
v_mul_f32 v223, v20, v223
v_cvt_pk_bf16_f32 v212, v216, v217
v_cvt_pk_bf16_f32 v213, v218, v219
v_cvt_pk_bf16_f32 v214, v220, v221
v_cvt_pk_bf16_f32 v215, v222, v223
s_nop 0
ds_read_b64_tr_b16 v[40:41], v5 offset:16384
ds_read_b64_tr_b16 v[42:43], v5 offset:18432
ds_read_b64_tr_b16 v[44:45], v5 offset:20480
ds_read_b64_tr_b16 v[46:47], v5 offset:22528
s_waitcnt lgkmcnt(0)
ds_read_b64_tr_b16 v[24:25], v5 offset:24576
ds_read_b64_tr_b16 v[26:27], v5 offset:26624
s_waitcnt lgkmcnt(0)
ds_read_b64_tr_b16 v[28:29], v5 offset:28672
ds_read_b64_tr_b16 v[30:31], v5 offset:30720
s_waitcnt lgkmcnt(0)
v_mfma_f32_16x16x32_bf16 v[232:235], v[40:43], v[160:163], v[232:235]
v_mfma_f32_16x16x32_bf16 v[232:235], v[44:47], v[168:171], v[232:235]
v_mfma_f32_16x16x32_bf16 v[232:235], v[24:27], v[176:179], v[232:235]
v_mfma_f32_16x16x32_bf16 v[232:235], v[28:31], v[184:187], v[232:235]
v_permlane16_swap_b32 v212, v214
v_permlane16_swap_b32 v213, v215
buffer_store_dwordx4 v[64:67], v14, s[24:27], s74 offen offset:0 sc1
v_mfma_f32_16x16x32_bf16 v[248:251], v[40:43], v[164:167], v[248:251]
v_mfma_f32_16x16x32_bf16 v[248:251], v[44:47], v[172:175], v[248:251]
v_mfma_f32_16x16x32_bf16 v[248:251], v[24:27], v[180:183], v[248:251]
v_mfma_f32_16x16x32_bf16 v[248:251], v[28:31], v[188:191], v[248:251]
s_not_b64 vcc, vcc
s_nop 0
v_cndmask_b32_dpp v72, v212, v208, vcc quad_perm:[1,0,3,2] row_mask:0xf bank_mask:0xf
v_cndmask_b32_dpp v74, v214, v210, vcc quad_perm:[1,0,3,2] row_mask:0xf bank_mask:0xf
v_cndmask_b32_dpp v73, v213, v209, vcc quad_perm:[1,0,3,2] row_mask:0xf bank_mask:0xf
v_cndmask_b32_dpp v75, v215, v211, vcc quad_perm:[1,0,3,2] row_mask:0xf bank_mask:0xf
s_not_b64 vcc, vcc
v_cndmask_b32_dpp v76, v208, v212, vcc quad_perm:[1,0,3,2] row_mask:0xf bank_mask:0xf
ds_read_b64_tr_b16 v[32:33], v7 offset:16384
ds_read_b64_tr_b16 v[34:35], v7 offset:18432
ds_read_b64_tr_b16 v[36:37], v7 offset:20480
ds_read_b64_tr_b16 v[38:39], v7 offset:22528
s_waitcnt lgkmcnt(0)
ds_read_b64_tr_b16 v[40:41], v7 offset:24576
ds_read_b64_tr_b16 v[42:43], v7 offset:26624
s_waitcnt lgkmcnt(0)
ds_read_b64_tr_b16 v[44:45], v7 offset:28672
ds_read_b64_tr_b16 v[46:47], v7 offset:30720
s_waitcnt lgkmcnt(0)
s_barrier
v_mfma_f32_16x16x32_bf16 v[236:239], v[32:35], v[160:163], v[236:239]
v_mfma_f32_16x16x32_bf16 v[236:239], v[36:39], v[168:171], v[236:239]
v_mfma_f32_16x16x32_bf16 v[236:239], v[40:43], v[176:179], v[236:239]
v_mfma_f32_16x16x32_bf16 v[236:239], v[44:47], v[184:187], v[236:239]
v_cndmask_b32_dpp v78, v210, v214, vcc quad_perm:[1,0,3,2] row_mask:0xf bank_mask:0xf
v_cndmask_b32_dpp v77, v209, v213, vcc quad_perm:[1,0,3,2] row_mask:0xf bank_mask:0xf
v_cndmask_b32_dpp v79, v211, v215, vcc quad_perm:[1,0,3,2] row_mask:0xf bank_mask:0xf
s_add_u32 m0, s32, 139264
s_xor_b32 s35, s33, 131200
buffer_load_dwordx4 v11, s[12:15], s35 offen nt lds
v_mfma_f32_16x16x32_bf16 v[252:255], v[32:35], v[164:167], v[252:255]
v_mfma_f32_16x16x32_bf16 v[252:255], v[36:39], v[172:175], v[252:255]
v_mfma_f32_16x16x32_bf16 v[252:255], v[40:43], v[180:183], v[252:255]
v_mfma_f32_16x16x32_bf16 v[252:255], v[44:47], v[188:191], v[252:255]
ds_read_b64_tr_b16 v[24:25], v4 offset:32768
ds_read_b64_tr_b16 v[26:27], v4 offset:34816
ds_read_b64_tr_b16 v[28:29], v4 offset:36864
ds_read_b64_tr_b16 v[30:31], v4 offset:38912
s_waitcnt lgkmcnt(0)
ds_read_b64_tr_b16 v[32:33], v4 offset:40960
ds_read_b64_tr_b16 v[34:35], v4 offset:43008
s_waitcnt lgkmcnt(0)
ds_read_b64_tr_b16 v[36:37], v4 offset:45056
ds_read_b64_tr_b16 v[38:39], v4 offset:47104
s_waitcnt lgkmcnt(0)
v_mfma_f32_16x16x32_bf16 v[192:195], v[24:27], v[128:131], 0
v_mfma_f32_16x16x32_bf16 v[192:195], v[28:31], v[136:139], v[192:195]
v_mfma_f32_16x16x32_bf16 v[192:195], v[32:35], v[144:147], v[192:195]
v_mfma_f32_16x16x32_bf16 v[192:195], v[36:39], v[152:155], v[192:195]
v_mfma_f32_16x16x32_bf16 v[208:211], v[24:27], v[132:135], 0
v_mfma_f32_16x16x32_bf16 v[208:211], v[28:31], v[140:143], v[208:211]
v_mfma_f32_16x16x32_bf16 v[208:211], v[32:35], v[148:151], v[208:211]
v_mfma_f32_16x16x32_bf16 v[208:211], v[36:39], v[156:159], v[208:211]
v_mul_f32 v224, v18, v224
v_mul_f32 v225, v18, v225
v_mul_f32 v226, v18, v226
v_mul_f32 v227, v18, v227
buffer_store_dwordx4 v[68:71], v14, s[24:27], s74 offen offset:512 sc1
ds_read_b64_tr_b16 v[40:41], v6 offset:32768
ds_read_b64_tr_b16 v[42:43], v6 offset:34816
ds_read_b64_tr_b16 v[44:45], v6 offset:36864
ds_read_b64_tr_b16 v[46:47], v6 offset:38912
s_waitcnt lgkmcnt(0)
ds_read_b64_tr_b16 v[24:25], v6 offset:40960
ds_read_b64_tr_b16 v[26:27], v6 offset:43008
s_waitcnt lgkmcnt(0)
ds_read_b64_tr_b16 v[28:29], v6 offset:45056
ds_read_b64_tr_b16 v[30:31], v6 offset:47104
s_waitcnt lgkmcnt(0)
v_mfma_f32_16x16x32_bf16 v[196:199], v[40:43], v[128:131], 0
v_mfma_f32_16x16x32_bf16 v[196:199], v[44:47], v[136:139], v[196:199]
v_mfma_f32_16x16x32_bf16 v[196:199], v[24:27], v[144:147], v[196:199]
v_mfma_f32_16x16x32_bf16 v[196:199], v[28:31], v[152:155], v[196:199]
v_mul_f32 v228, v18, v228
v_mul_f32 v229, v18, v229
v_mul_f32 v230, v18, v230
v_mul_f32 v231, v18, v231
v_cvt_pk_bf16_f32 v224, v224, v225
v_cvt_pk_bf16_f32 v225, v226, v227
v_cvt_pk_bf16_f32 v226, v228, v229
v_cvt_pk_bf16_f32 v227, v230, v231
v_mfma_f32_16x16x32_bf16 v[212:215], v[40:43], v[132:135], 0
v_mfma_f32_16x16x32_bf16 v[212:215], v[44:47], v[140:143], v[212:215]
v_mfma_f32_16x16x32_bf16 v[212:215], v[24:27], v[148:151], v[212:215]
v_mfma_f32_16x16x32_bf16 v[212:215], v[28:31], v[156:159], v[212:215]
v_mul_f32 v232, v18, v232
v_mul_f32 v233, v18, v233
v_mul_f32 v234, v18, v234
v_permlane16_swap_b32 v224, v226
s_add_u32 m0, s32, 147456
s_xor_b32 s35, s33, 139392
buffer_load_dwordx4 v10, s[12:15], s35 offen nt lds
ds_read_b64_tr_b16 v[32:33], v5 offset:32768
ds_read_b64_tr_b16 v[34:35], v5 offset:34816
ds_read_b64_tr_b16 v[36:37], v5 offset:36864
ds_read_b64_tr_b16 v[38:39], v5 offset:38912
s_waitcnt lgkmcnt(0)
ds_read_b64_tr_b16 v[40:41], v5 offset:40960
ds_read_b64_tr_b16 v[42:43], v5 offset:43008
s_waitcnt lgkmcnt(0)
ds_read_b64_tr_b16 v[44:45], v5 offset:45056
ds_read_b64_tr_b16 v[46:47], v5 offset:47104
s_waitcnt lgkmcnt(0)
v_mfma_f32_16x16x32_bf16 v[200:203], v[32:35], v[128:131], 0
v_mfma_f32_16x16x32_bf16 v[200:203], v[36:39], v[136:139], v[200:203]
v_mfma_f32_16x16x32_bf16 v[200:203], v[40:43], v[144:147], v[200:203]
v_mfma_f32_16x16x32_bf16 v[200:203], v[44:47], v[152:155], v[200:203]
v_mul_f32 v235, v18, v235
v_mul_f32 v236, v18, v236
v_mul_f32 v237, v18, v237
v_mul_f32 v238, v18, v238
v_mul_f32 v239, v18, v239
v_permlane16_swap_b32 v225, v227
v_mfma_f32_16x16x32_bf16 v[216:219], v[32:35], v[132:135], 0
v_mfma_f32_16x16x32_bf16 v[216:219], v[36:39], v[140:143], v[216:219]
v_mfma_f32_16x16x32_bf16 v[216:219], v[40:43], v[148:151], v[216:219]
v_mfma_f32_16x16x32_bf16 v[216:219], v[44:47], v[156:159], v[216:219]
v_cvt_pk_bf16_f32 v228, v232, v233
v_cvt_pk_bf16_f32 v229, v234, v235
v_cvt_pk_bf16_f32 v230, v236, v237
v_cvt_pk_bf16_f32 v231, v238, v239
v_mul_f32 v240, v20, v240
v_mul_f32 v241, v20, v241
buffer_store_dwordx4 v[72:75], v14, s[24:27], s75 offen offset:0 sc1
ds_read_b64_tr_b16 v[24:25], v7 offset:32768
ds_read_b64_tr_b16 v[26:27], v7 offset:34816
ds_read_b64_tr_b16 v[28:29], v7 offset:36864
ds_read_b64_tr_b16 v[30:31], v7 offset:38912
s_waitcnt lgkmcnt(0)
ds_read_b64_tr_b16 v[32:33], v7 offset:40960
ds_read_b64_tr_b16 v[34:35], v7 offset:43008
s_waitcnt lgkmcnt(0)
ds_read_b64_tr_b16 v[36:37], v7 offset:45056
ds_read_b64_tr_b16 v[38:39], v7 offset:47104
s_waitcnt lgkmcnt(0)
s_barrier
v_mfma_f32_16x16x32_bf16 v[204:207], v[24:27], v[128:131], 0
v_mfma_f32_16x16x32_bf16 v[204:207], v[28:31], v[136:139], v[204:207]
v_mfma_f32_16x16x32_bf16 v[204:207], v[32:35], v[144:147], v[204:207]
v_mfma_f32_16x16x32_bf16 v[204:207], v[36:39], v[152:155], v[204:207]
v_mul_f32 v242, v20, v242
v_permlane16_swap_b32 v228, v230
v_mul_f32 v243, v20, v243
v_permlane16_swap_b32 v229, v231
v_mfma_f32_16x16x32_bf16 v[220:223], v[24:27], v[132:135], 0
v_mfma_f32_16x16x32_bf16 v[220:223], v[28:31], v[140:143], v[220:223]
v_mfma_f32_16x16x32_bf16 v[220:223], v[32:35], v[148:151], v[220:223]
v_mfma_f32_16x16x32_bf16 v[220:223], v[36:39], v[156:159], v[220:223]
v_mul_f32 v244, v20, v244
s_mov_b64 vcc, s[62:63]
v_cndmask_b32_dpp v96, v228, v224, vcc quad_perm:[1,0,3,2] row_mask:0xf bank_mask:0xf
v_mul_f32 v245, v20, v245
v_cndmask_b32_dpp v98, v230, v226, vcc quad_perm:[1,0,3,2] row_mask:0xf bank_mask:0xf
v_mul_f32 v246, v20, v246
v_cndmask_b32_dpp v97, v229, v225, vcc quad_perm:[1,0,3,2] row_mask:0xf bank_mask:0xf
v_mul_f32 v247, v20, v247
ds_read_b64_tr_b16 v[40:41], v4 offset:49152
ds_read_b64_tr_b16 v[42:43], v4 offset:51200
ds_read_b64_tr_b16 v[44:45], v4 offset:53248
ds_read_b64_tr_b16 v[46:47], v4 offset:55296
s_waitcnt lgkmcnt(0)
ds_read_b64_tr_b16 v[24:25], v4 offset:57344
ds_read_b64_tr_b16 v[26:27], v4 offset:59392
s_waitcnt lgkmcnt(0)
ds_read_b64_tr_b16 v[28:29], v4 offset:61440
ds_read_b64_tr_b16 v[30:31], v4 offset:63488
s_waitcnt lgkmcnt(0)
v_mfma_f32_16x16x32_bf16 v[192:195], v[40:43], v[160:163], v[192:195]
v_mfma_f32_16x16x32_bf16 v[192:195], v[44:47], v[168:171], v[192:195]
v_mfma_f32_16x16x32_bf16 v[192:195], v[24:27], v[176:179], v[192:195]
v_mfma_f32_16x16x32_bf16 v[192:195], v[28:31], v[184:187], v[192:195]
v_cndmask_b32_dpp v99, v231, v227, vcc quad_perm:[1,0,3,2] row_mask:0xf bank_mask:0xf
v_cvt_pk_bf16_f32 v240, v240, v241
v_cvt_pk_bf16_f32 v241, v242, v243
v_cvt_pk_bf16_f32 v242, v244, v245
v_cvt_pk_bf16_f32 v243, v246, v247
v_mul_f32 v248, v20, v248
s_not_b64 vcc, vcc
v_cndmask_b32_dpp v100, v224, v228, vcc quad_perm:[1,0,3,2] row_mask:0xf bank_mask:0xf
s_add_u32 m0, s32, 155648
s_xor_b32 s35, s33, 139392
buffer_load_dwordx4 v11, s[12:15], s35 offen nt lds
v_mfma_f32_16x16x32_bf16 v[208:211], v[40:43], v[164:167], v[208:211]
v_mfma_f32_16x16x32_bf16 v[208:211], v[44:47], v[172:175], v[208:211]
v_mfma_f32_16x16x32_bf16 v[208:211], v[24:27], v[180:183], v[208:211]
v_mfma_f32_16x16x32_bf16 v[208:211], v[28:31], v[188:191], v[208:211]
v_mul_f32 v249, v20, v249
v_cndmask_b32_dpp v102, v226, v230, vcc quad_perm:[1,0,3,2] row_mask:0xf bank_mask:0xf
v_mul_f32 v250, v20, v250
v_cndmask_b32_dpp v101, v225, v229, vcc quad_perm:[1,0,3,2] row_mask:0xf bank_mask:0xf
v_mul_f32 v251, v20, v251
v_cndmask_b32_dpp v103, v227, v231, vcc quad_perm:[1,0,3,2] row_mask:0xf bank_mask:0xf
v_mul_f32 v252, v20, v252
ds_read_b64_tr_b16 v[32:33], v6 offset:49152
ds_read_b64_tr_b16 v[34:35], v6 offset:51200
ds_read_b64_tr_b16 v[36:37], v6 offset:53248
ds_read_b64_tr_b16 v[38:39], v6 offset:55296
s_waitcnt lgkmcnt(0)
ds_read_b64_tr_b16 v[40:41], v6 offset:57344
ds_read_b64_tr_b16 v[42:43], v6 offset:59392
s_waitcnt lgkmcnt(0)
ds_read_b64_tr_b16 v[44:45], v6 offset:61440
ds_read_b64_tr_b16 v[46:47], v6 offset:63488
s_waitcnt lgkmcnt(0)
v_mfma_f32_16x16x32_bf16 v[196:199], v[32:35], v[160:163], v[196:199]
v_mfma_f32_16x16x32_bf16 v[196:199], v[36:39], v[168:171], v[196:199]
v_mfma_f32_16x16x32_bf16 v[196:199], v[40:43], v[176:179], v[196:199]
v_mfma_f32_16x16x32_bf16 v[196:199], v[44:47], v[184:187], v[196:199]
v_mul_f32 v253, v20, v253
v_permlane16_swap_b32 v240, v242
v_mul_f32 v254, v20, v254
v_permlane16_swap_b32 v241, v243
buffer_store_dwordx4 v[76:79], v14, s[24:27], s75 offen offset:512 sc1
v_mfma_f32_16x16x32_bf16 v[212:215], v[32:35], v[164:167], v[212:215]
v_mfma_f32_16x16x32_bf16 v[212:215], v[36:39], v[172:175], v[212:215]
v_mfma_f32_16x16x32_bf16 v[212:215], v[40:43], v[180:183], v[212:215]
v_mfma_f32_16x16x32_bf16 v[212:215], v[44:47], v[188:191], v[212:215]
v_mul_f32 v255, v20, v255
v_cvt_pk_bf16_f32 v244, v248, v249
v_cvt_pk_bf16_f32 v245, v250, v251
v_cvt_pk_bf16_f32 v246, v252, v253
v_cvt_pk_bf16_f32 v247, v254, v255
s_nop 0
ds_read_b64_tr_b16 v[24:25], v5 offset:49152
ds_read_b64_tr_b16 v[26:27], v5 offset:51200
ds_read_b64_tr_b16 v[28:29], v5 offset:53248
ds_read_b64_tr_b16 v[30:31], v5 offset:55296
s_waitcnt lgkmcnt(0)
ds_read_b64_tr_b16 v[32:33], v5 offset:57344
ds_read_b64_tr_b16 v[34:35], v5 offset:59392
s_waitcnt lgkmcnt(0)
ds_read_b64_tr_b16 v[36:37], v5 offset:61440
ds_read_b64_tr_b16 v[38:39], v5 offset:63488
s_waitcnt lgkmcnt(0)
v_mfma_f32_16x16x32_bf16 v[200:203], v[24:27], v[160:163], v[200:203]
v_mfma_f32_16x16x32_bf16 v[200:203], v[28:31], v[168:171], v[200:203]
v_mfma_f32_16x16x32_bf16 v[200:203], v[32:35], v[176:179], v[200:203]
v_mfma_f32_16x16x32_bf16 v[200:203], v[36:39], v[184:187], v[200:203]
v_permlane16_swap_b32 v244, v246
v_permlane16_swap_b32 v245, v247
s_add_u32 m0, s32, 49152
s_xor_b32 s35, s34, 196736
buffer_load_dwordx4 v12, s[16:19], s35 offen nt lds
v_mfma_f32_16x16x32_bf16 v[216:219], v[24:27], v[164:167], v[216:219]
v_mfma_f32_16x16x32_bf16 v[216:219], v[28:31], v[172:175], v[216:219]
v_mfma_f32_16x16x32_bf16 v[216:219], v[32:35], v[180:183], v[216:219]
v_mfma_f32_16x16x32_bf16 v[216:219], v[36:39], v[188:191], v[216:219]
s_not_b64 vcc, vcc
s_nop 0
v_cndmask_b32_dpp v104, v244, v240, vcc quad_perm:[1,0,3,2] row_mask:0xf bank_mask:0xf
v_cndmask_b32_dpp v106, v246, v242, vcc quad_perm:[1,0,3,2] row_mask:0xf bank_mask:0xf
v_cndmask_b32_dpp v105, v245, v241, vcc quad_perm:[1,0,3,2] row_mask:0xf bank_mask:0xf
v_cndmask_b32_dpp v107, v247, v243, vcc quad_perm:[1,0,3,2] row_mask:0xf bank_mask:0xf
s_not_b64 vcc, vcc
v_cndmask_b32_dpp v108, v240, v244, vcc quad_perm:[1,0,3,2] row_mask:0xf bank_mask:0xf
ds_read_b64_tr_b16 v[40:41], v7 offset:49152
ds_read_b64_tr_b16 v[42:43], v7 offset:51200
ds_read_b64_tr_b16 v[44:45], v7 offset:53248
ds_read_b64_tr_b16 v[46:47], v7 offset:55296
s_waitcnt lgkmcnt(0)
ds_read_b64_tr_b16 v[24:25], v7 offset:57344
ds_read_b64_tr_b16 v[26:27], v7 offset:59392
s_waitcnt lgkmcnt(0)
ds_read_b64_tr_b16 v[28:29], v7 offset:61440
ds_read_b64_tr_b16 v[30:31], v7 offset:63488
s_waitcnt lgkmcnt(0)
v_mfma_f32_16x16x32_bf16 v[204:207], v[40:43], v[160:163], v[204:207]
v_mfma_f32_16x16x32_bf16 v[204:207], v[44:47], v[168:171], v[204:207]
v_mfma_f32_16x16x32_bf16 v[204:207], v[24:27], v[176:179], v[204:207]
v_mfma_f32_16x16x32_bf16 v[204:207], v[28:31], v[184:187], v[204:207]
v_cndmask_b32_dpp v110, v242, v246, vcc quad_perm:[1,0,3,2] row_mask:0xf bank_mask:0xf
v_cndmask_b32_dpp v109, v241, v245, vcc quad_perm:[1,0,3,2] row_mask:0xf bank_mask:0xf
v_cndmask_b32_dpp v111, v243, v247, vcc quad_perm:[1,0,3,2] row_mask:0xf bank_mask:0xf
v_mfma_f32_16x16x32_bf16 v[220:223], v[40:43], v[164:167], v[220:223]
v_mfma_f32_16x16x32_bf16 v[220:223], v[44:47], v[172:175], v[220:223]
v_mfma_f32_16x16x32_bf16 v[220:223], v[24:27], v[180:183], v[220:223]
v_mfma_f32_16x16x32_bf16 v[220:223], v[28:31], v[188:191], v[220:223]
s_add_u32 m0, s32, 57344
s_xor_b32 s35, s34, 229504
buffer_load_dwordx4 v12, s[16:19], s35 offen nt lds
v_xor_b32 v4, 0x10000, v4
v_xor_b32 v5, 0x10000, v5
v_xor_b32 v6, 0x10000, v6
v_xor_b32 v7, 0x10000, v7
L_qb_sel:
s_lshr_b32 s61, 85, s38
s_bitcmp1_b32 s61, 0
s_cbranch_scc1 L_qb1
L_qb0:
s_waitcnt vmcnt(18)
s_barrier
ds_read_b128 v[24:27], v0 offset:0
s_waitcnt lgkmcnt(0)
ds_read_b128 v[28:31], v1 offset:0
s_waitcnt lgkmcnt(0)
v_mfma_f32_16x16x32_bf16 v[128:131], v[24:27], v[48:51], 0
v_mfma_f32_16x16x32_bf16 v[128:131], v[28:31], v[52:55], v[128:131]
v_mul_f32 v192, v18, v192
v_mul_f32 v193, v18, v193
v_mul_f32 v194, v18, v194
v_mul_f32 v195, v18, v195
v_mul_f32 v196, v18, v196
v_mul_f32 v197, v18, v197
v_mul_f32 v198, v18, v198
v_mul_f32 v199, v18, v199
v_mfma_f32_16x16x32_bf16 v[136:139], v[24:27], v[56:59], 0
v_mfma_f32_16x16x32_bf16 v[136:139], v[28:31], v[60:63], v[136:139]
ds_read_b128 v[32:35], v0 offset:2048
v_cvt_pk_bf16_f32 v192, v192, v193
v_cvt_pk_bf16_f32 v193, v194, v195
v_cvt_pk_bf16_f32 v194, v196, v197
v_cvt_pk_bf16_f32 v195, v198, v199
v_mul_f32 v200, v18, v200
v_mul_f32 v201, v18, v201
v_permlane16_swap_b32 v192, v194
s_waitcnt lgkmcnt(0)
ds_read_b128 v[36:39], v1 offset:2048
s_waitcnt lgkmcnt(0)
v_mfma_f32_16x16x32_bf16 v[132:135], v[32:35], v[48:51], 0
v_mfma_f32_16x16x32_bf16 v[132:135], v[36:39], v[52:55], v[132:135]
v_mul_f32 v202, v18, v202
v_mul_f32 v203, v18, v203
v_mul_f32 v204, v18, v204
v_mul_f32 v205, v18, v205
v_mul_f32 v206, v18, v206
v_permlane16_swap_b32 v193, v195
v_mul_f32 v207, v18, v207
v_mfma_f32_16x16x32_bf16 v[140:143], v[32:35], v[56:59], 0
v_mfma_f32_16x16x32_bf16 v[140:143], v[36:39], v[60:63], v[140:143]
ds_read_b128 v[40:43], v0 offset:4096
v_cvt_pk_bf16_f32 v196, v200, v201
v_cvt_pk_bf16_f32 v197, v202, v203
v_cvt_pk_bf16_f32 v198, v204, v205
v_cvt_pk_bf16_f32 v199, v206, v207
v_mul_f32 v208, v20, v208
v_mul_f32 v209, v20, v209
v_permlane16_swap_b32 v196, v198
s_waitcnt lgkmcnt(0)
ds_read_b128 v[44:47], v1 offset:4096
s_waitcnt lgkmcnt(0)
v_mfma_f32_16x16x32_bf16 v[144:147], v[40:43], v[48:51], 0
v_mfma_f32_16x16x32_bf16 v[144:147], v[44:47], v[52:55], v[144:147]
v_mul_f32 v210, v20, v210
v_permlane16_swap_b32 v197, v199
v_mul_f32 v211, v20, v211
v_mul_f32 v212, v20, v212
s_mov_b64 vcc, s[62:63]
v_cndmask_b32_dpp v112, v196, v192, vcc quad_perm:[1,0,3,2] row_mask:0xf bank_mask:0xf
v_mul_f32 v213, v20, v213
v_cndmask_b32_dpp v114, v198, v194, vcc quad_perm:[1,0,3,2] row_mask:0xf bank_mask:0xf
v_mfma_f32_16x16x32_bf16 v[152:155], v[40:43], v[56:59], 0
v_mfma_f32_16x16x32_bf16 v[152:155], v[44:47], v[60:63], v[152:155]
ds_read_b128 v[24:27], v0 offset:6144
v_mul_f32 v214, v20, v214
v_cndmask_b32_dpp v113, v197, v193, vcc quad_perm:[1,0,3,2] row_mask:0xf bank_mask:0xf
v_mul_f32 v215, v20, v215
v_cndmask_b32_dpp v115, v199, v195, vcc quad_perm:[1,0,3,2] row_mask:0xf bank_mask:0xf
v_cvt_pk_bf16_f32 v208, v208, v209
v_cvt_pk_bf16_f32 v209, v210, v211
v_cvt_pk_bf16_f32 v210, v212, v213
v_cvt_pk_bf16_f32 v211, v214, v215
s_waitcnt vmcnt(7)
ds_read_b128 v[64:67], v8 offset:0
ds_read_b128 v[68:71], v9 offset:0
s_waitcnt lgkmcnt(0)
s_waitcnt vmcnt(4)
s_add_u32 m0, s32, 131072
s_xor_b32 s35, s33, 131328
buffer_load_dwordx4 v10, s[12:15], s35 offen nt lds
ds_read_b128 v[28:31], v1 offset:6144
s_waitcnt lgkmcnt(0)
v_mfma_f32_16x16x32_bf16 v[148:151], v[24:27], v[48:51], 0
v_mfma_f32_16x16x32_bf16 v[148:151], v[28:31], v[52:55], v[148:151]
v_mul_f32 v216, v20, v216
s_not_b64 vcc, vcc
v_cndmask_b32_dpp v116, v192, v196, vcc quad_perm:[1,0,3,2] row_mask:0xf bank_mask:0xf
v_mul_f32 v217, v20, v217
v_cndmask_b32_dpp v118, v194, v198, vcc quad_perm:[1,0,3,2] row_mask:0xf bank_mask:0xf
v_mul_f32 v218, v20, v218
v_cndmask_b32_dpp v117, v193, v197, vcc quad_perm:[1,0,3,2] row_mask:0xf bank_mask:0xf
v_mul_f32 v219, v20, v219
v_cndmask_b32_dpp v119, v195, v199, vcc quad_perm:[1,0,3,2] row_mask:0xf bank_mask:0xf
v_mfma_f32_16x16x32_bf16 v[156:159], v[24:27], v[56:59], 0
v_mfma_f32_16x16x32_bf16 v[156:159], v[28:31], v[60:63], v[156:159]
ds_read_b128 v[32:35], v0 offset:8192
v_mul_f32 v220, v20, v220
v_permlane16_swap_b32 v208, v210
v_mul_f32 v221, v20, v221
v_permlane16_swap_b32 v209, v211
v_mul_f32 v222, v20, v222
v_mul_f32 v223, v20, v223
s_waitcnt lgkmcnt(0)
ds_read_b128 v[36:39], v1 offset:8192
s_waitcnt lgkmcnt(0)
v_mfma_f32_16x16x32_bf16 v[160:163], v[32:35], v[48:51], 0
v_mfma_f32_16x16x32_bf16 v[160:163], v[36:39], v[52:55], v[160:163]
v_cvt_pk_bf16_f32 v212, v216, v217
v_cvt_pk_bf16_f32 v213, v218, v219
v_cvt_pk_bf16_f32 v214, v220, v221
v_cvt_pk_bf16_f32 v215, v222, v223
s_nop 0
v_permlane16_swap_b32 v212, v214
v_permlane16_swap_b32 v213, v215
v_mfma_f32_16x16x32_bf16 v[168:171], v[32:35], v[56:59], 0
v_mfma_f32_16x16x32_bf16 v[168:171], v[36:39], v[60:63], v[168:171]
ds_read_b128 v[40:43], v0 offset:10240
s_not_b64 vcc, vcc
s_nop 0
v_cndmask_b32_dpp v120, v212, v208, vcc quad_perm:[1,0,3,2] row_mask:0xf bank_mask:0xf
v_cndmask_b32_dpp v122, v214, v210, vcc quad_perm:[1,0,3,2] row_mask:0xf bank_mask:0xf
v_cndmask_b32_dpp v121, v213, v209, vcc quad_perm:[1,0,3,2] row_mask:0xf bank_mask:0xf
v_cndmask_b32_dpp v123, v215, v211, vcc quad_perm:[1,0,3,2] row_mask:0xf bank_mask:0xf
s_not_b64 vcc, vcc
v_cndmask_b32_dpp v124, v208, v212, vcc quad_perm:[1,0,3,2] row_mask:0xf bank_mask:0xf
v_cndmask_b32_dpp v126, v210, v214, vcc quad_perm:[1,0,3,2] row_mask:0xf bank_mask:0xf
v_cndmask_b32_dpp v125, v209, v213, vcc quad_perm:[1,0,3,2] row_mask:0xf bank_mask:0xf
v_cndmask_b32_dpp v127, v211, v215, vcc quad_perm:[1,0,3,2] row_mask:0xf bank_mask:0xf
s_waitcnt lgkmcnt(0)
ds_read_b128 v[44:47], v1 offset:10240
s_waitcnt lgkmcnt(0)
v_mfma_f32_16x16x32_bf16 v[164:167], v[40:43], v[48:51], 0
v_mfma_f32_16x16x32_bf16 v[164:167], v[44:47], v[52:55], v[164:167]
v_mfma_f32_16x16x32_bf16 v[172:175], v[40:43], v[56:59], 0
v_mfma_f32_16x16x32_bf16 v[172:175], v[44:47], v[60:63], v[172:175]
ds_read_b128 v[24:27], v0 offset:12288
s_waitcnt vmcnt(4)
s_add_u32 m0, s32, 139264
s_xor_b32 s35, s33, 131328
buffer_load_dwordx4 v11, s[12:15], s35 offen nt lds
s_waitcnt lgkmcnt(0)
ds_read_b128 v[28:31], v1 offset:12288
s_waitcnt lgkmcnt(0)
v_mfma_f32_16x16x32_bf16 v[176:179], v[24:27], v[48:51], 0
v_mfma_f32_16x16x32_bf16 v[176:179], v[28:31], v[52:55], v[176:179]
v_mfma_f32_16x16x32_bf16 v[184:187], v[24:27], v[56:59], 0
v_mfma_f32_16x16x32_bf16 v[184:187], v[28:31], v[60:63], v[184:187]
ds_read_b128 v[32:35], v0 offset:14336
s_waitcnt lgkmcnt(0)
ds_read_b128 v[36:39], v1 offset:14336
s_waitcnt lgkmcnt(0)
v_mfma_f32_16x16x32_bf16 v[180:183], v[32:35], v[48:51], 0
v_mfma_f32_16x16x32_bf16 v[180:183], v[36:39], v[52:55], v[180:183]
v_mfma_f32_16x16x32_bf16 v[188:191], v[32:35], v[56:59], 0
v_mfma_f32_16x16x32_bf16 v[188:191], v[36:39], v[60:63], v[188:191]
s_barrier
ds_read_b128 v[40:43], v0 offset:16384
s_waitcnt lgkmcnt(0)
ds_read_b128 v[44:47], v1 offset:16384
s_waitcnt lgkmcnt(0)
v_mfma_f32_16x16x32_bf16 v[192:195], v[40:43], v[48:51], 0
v_mfma_f32_16x16x32_bf16 v[192:195], v[44:47], v[52:55], v[192:195]
v_mfma_f32_16x16x32_bf16 v[200:203], v[40:43], v[56:59], 0
v_mfma_f32_16x16x32_bf16 v[200:203], v[44:47], v[60:63], v[200:203]
ds_read_b128 v[24:27], v0 offset:18432
s_waitcnt vmcnt(4)
s_add_u32 m0, s32, 65536
s_xor_b32 s35, s34, 131328
buffer_load_dwordx4 v12, s[16:19], s35 offen nt lds
s_waitcnt lgkmcnt(0)
ds_read_b128 v[28:31], v1 offset:18432
s_waitcnt lgkmcnt(0)
v_mfma_f32_16x16x32_bf16 v[196:199], v[24:27], v[48:51], 0
v_mfma_f32_16x16x32_bf16 v[196:199], v[28:31], v[52:55], v[196:199]
v_mfma_f32_16x16x32_bf16 v[204:207], v[24:27], v[56:59], 0
v_mfma_f32_16x16x32_bf16 v[204:207], v[28:31], v[60:63], v[204:207]
ds_read_b128 v[32:35], v0 offset:20480
s_waitcnt lgkmcnt(0)
ds_read_b128 v[36:39], v1 offset:20480
s_waitcnt lgkmcnt(0)
v_mfma_f32_16x16x32_bf16 v[208:211], v[32:35], v[48:51], 0
v_mfma_f32_16x16x32_bf16 v[208:211], v[36:39], v[52:55], v[208:211]
v_mfma_f32_16x16x32_bf16 v[216:219], v[32:35], v[56:59], 0
v_mfma_f32_16x16x32_bf16 v[216:219], v[36:39], v[60:63], v[216:219]
ds_read_b128 v[40:43], v0 offset:22528
s_waitcnt lgkmcnt(0)
ds_read_b128 v[44:47], v1 offset:22528
s_waitcnt lgkmcnt(0)
v_mfma_f32_16x16x32_bf16 v[212:215], v[40:43], v[48:51], 0
v_mfma_f32_16x16x32_bf16 v[212:215], v[44:47], v[52:55], v[212:215]
v_mfma_f32_16x16x32_bf16 v[220:223], v[40:43], v[56:59], 0
v_mfma_f32_16x16x32_bf16 v[220:223], v[44:47], v[60:63], v[220:223]
ds_read_b128 v[24:27], v0 offset:24576
ds_read_b128 v[72:75], v8 offset:16384
ds_read_b128 v[76:79], v9 offset:16384
s_waitcnt lgkmcnt(0)
s_waitcnt vmcnt(4)
s_add_u32 m0, s32, 147456
s_xor_b32 s35, s33, 139520
buffer_load_dwordx4 v10, s[12:15], s35 offen nt lds
ds_read_b128 v[28:31], v1 offset:24576
s_waitcnt lgkmcnt(0)
v_mfma_f32_16x16x32_bf16 v[224:227], v[24:27], v[48:51], 0
v_mfma_f32_16x16x32_bf16 v[224:227], v[28:31], v[52:55], v[224:227]
v_mfma_f32_16x16x32_bf16 v[232:235], v[24:27], v[56:59], 0
v_mfma_f32_16x16x32_bf16 v[232:235], v[28:31], v[60:63], v[232:235]
ds_read_b128 v[32:35], v0 offset:26624
s_waitcnt lgkmcnt(0)
ds_read_b128 v[36:39], v1 offset:26624
s_waitcnt lgkmcnt(0)
v_mfma_f32_16x16x32_bf16 v[228:231], v[32:35], v[48:51], 0
v_mfma_f32_16x16x32_bf16 v[228:231], v[36:39], v[52:55], v[228:231]
v_mfma_f32_16x16x32_bf16 v[236:239], v[32:35], v[56:59], 0
v_mfma_f32_16x16x32_bf16 v[236:239], v[36:39], v[60:63], v[236:239]
ds_read_b128 v[40:43], v0 offset:28672
s_waitcnt vmcnt(4)
s_add_u32 m0, s32, 73728
s_xor_b32 s35, s34, 164096
buffer_load_dwordx4 v12, s[16:19], s35 offen nt lds
s_waitcnt lgkmcnt(0)
ds_read_b128 v[44:47], v1 offset:28672
s_waitcnt lgkmcnt(0)
v_mfma_f32_16x16x32_bf16 v[240:243], v[40:43], v[48:51], 0
v_mfma_f32_16x16x32_bf16 v[240:243], v[44:47], v[52:55], v[240:243]
v_mfma_f32_16x16x32_bf16 v[248:251], v[40:43], v[56:59], 0
v_mfma_f32_16x16x32_bf16 v[248:251], v[44:47], v[60:63], v[248:251]
ds_read_b128 v[24:27], v0 offset:30720
s_waitcnt lgkmcnt(0)
ds_read_b128 v[28:31], v1 offset:30720
s_waitcnt lgkmcnt(0)
v_mfma_f32_16x16x32_bf16 v[244:247], v[24:27], v[48:51], 0
v_mfma_f32_16x16x32_bf16 v[244:247], v[28:31], v[52:55], v[244:247]
v_mfma_f32_16x16x32_bf16 v[252:255], v[24:27], v[56:59], 0
v_mfma_f32_16x16x32_bf16 v[252:255], v[28:31], v[60:63], v[252:255]
s_barrier
ds_read_b128 v[32:35], v0 offset:32768
s_waitcnt lgkmcnt(0)
ds_read_b128 v[36:39], v1 offset:32768
s_waitcnt lgkmcnt(0)
v_mfma_f32_16x16x32_bf16 v[128:131], v[32:35], v[64:67], v[128:131]
v_mfma_f32_16x16x32_bf16 v[128:131], v[36:39], v[68:71], v[128:131]
v_mfma_f32_16x16x32_bf16 v[136:139], v[32:35], v[72:75], v[136:139]
v_mfma_f32_16x16x32_bf16 v[136:139], v[36:39], v[76:79], v[136:139]
ds_read_b128 v[40:43], v0 offset:34816
s_waitcnt vmcnt(4)
s_add_u32 m0, s32, 155648
s_xor_b32 s35, s33, 139520
buffer_load_dwordx4 v11, s[12:15], s35 offen nt lds
s_waitcnt lgkmcnt(0)
ds_read_b128 v[44:47], v1 offset:34816
s_waitcnt lgkmcnt(0)
v_mfma_f32_16x16x32_bf16 v[132:135], v[40:43], v[64:67], v[132:135]
v_mfma_f32_16x16x32_bf16 v[132:135], v[44:47], v[68:71], v[132:135]
v_mfma_f32_16x16x32_bf16 v[140:143], v[40:43], v[72:75], v[140:143]
v_mfma_f32_16x16x32_bf16 v[140:143], v[44:47], v[76:79], v[140:143]
ds_read_b128 v[24:27], v0 offset:36864
s_waitcnt lgkmcnt(0)
ds_read_b128 v[28:31], v1 offset:36864
s_waitcnt lgkmcnt(0)
v_mfma_f32_16x16x32_bf16 v[144:147], v[24:27], v[64:67], v[144:147]
v_mfma_f32_16x16x32_bf16 v[144:147], v[28:31], v[68:71], v[144:147]
v_mfma_f32_16x16x32_bf16 v[152:155], v[24:27], v[72:75], v[152:155]
v_mfma_f32_16x16x32_bf16 v[152:155], v[28:31], v[76:79], v[152:155]
ds_read_b128 v[32:35], v0 offset:38912
s_waitcnt vmcnt(3)
s_add_u32 m0, s32, 81920
s_xor_b32 s35, s34, 196864
buffer_load_dwordx4 v12, s[16:19], s35 offen nt lds
s_waitcnt lgkmcnt(0)
ds_read_b128 v[36:39], v1 offset:38912
s_waitcnt lgkmcnt(0)
v_mfma_f32_16x16x32_bf16 v[148:151], v[32:35], v[64:67], v[148:151]
v_mfma_f32_16x16x32_bf16 v[148:151], v[36:39], v[68:71], v[148:151]
v_mfma_f32_16x16x32_bf16 v[156:159], v[32:35], v[72:75], v[156:159]
v_mfma_f32_16x16x32_bf16 v[156:159], v[36:39], v[76:79], v[156:159]
ds_read_b128 v[40:43], v0 offset:40960
s_waitcnt lgkmcnt(0)
ds_read_b128 v[44:47], v1 offset:40960
s_waitcnt lgkmcnt(0)
v_mfma_f32_16x16x32_bf16 v[160:163], v[40:43], v[64:67], v[160:163]
v_mfma_f32_16x16x32_bf16 v[160:163], v[44:47], v[68:71], v[160:163]
v_mfma_f32_16x16x32_bf16 v[168:171], v[40:43], v[72:75], v[168:171]
v_mfma_f32_16x16x32_bf16 v[168:171], v[44:47], v[76:79], v[168:171]
ds_read_b128 v[24:27], v0 offset:43008
s_waitcnt lgkmcnt(0)
ds_read_b128 v[28:31], v1 offset:43008
s_waitcnt lgkmcnt(0)
v_mfma_f32_16x16x32_bf16 v[164:167], v[24:27], v[64:67], v[164:167]
v_mfma_f32_16x16x32_bf16 v[164:167], v[28:31], v[68:71], v[164:167]
v_mfma_f32_16x16x32_bf16 v[172:175], v[24:27], v[72:75], v[172:175]
v_mfma_f32_16x16x32_bf16 v[172:175], v[28:31], v[76:79], v[172:175]
ds_read_b128 v[32:35], v0 offset:45056
ds_read_b128 v[48:51], v8 offset:0
ds_read_b128 v[52:55], v9 offset:0
s_waitcnt lgkmcnt(0)
s_waitcnt vmcnt(3)
s_add_u32 m0, s32, 131072
s_xor_b32 s35, s33, 131456
buffer_load_dwordx4 v10, s[12:15], s35 offen nt lds
ds_read_b128 v[36:39], v1 offset:45056
s_waitcnt lgkmcnt(0)
v_mfma_f32_16x16x32_bf16 v[176:179], v[32:35], v[64:67], v[176:179]
v_mfma_f32_16x16x32_bf16 v[176:179], v[36:39], v[68:71], v[176:179]
v_mfma_f32_16x16x32_bf16 v[184:187], v[32:35], v[72:75], v[184:187]
v_mfma_f32_16x16x32_bf16 v[184:187], v[36:39], v[76:79], v[184:187]
ds_read_b128 v[40:43], v0 offset:47104
s_waitcnt lgkmcnt(0)
ds_read_b128 v[44:47], v1 offset:47104
s_waitcnt lgkmcnt(0)
v_mfma_f32_16x16x32_bf16 v[180:183], v[40:43], v[64:67], v[180:183]
v_mfma_f32_16x16x32_bf16 v[180:183], v[44:47], v[68:71], v[180:183]
v_mfma_f32_16x16x32_bf16 v[188:191], v[40:43], v[72:75], v[188:191]
v_mfma_f32_16x16x32_bf16 v[188:191], v[44:47], v[76:79], v[188:191]
s_waitcnt vmcnt(3)
s_add_u32 m0, s32, 90112
s_xor_b32 s35, s34, 229632
buffer_load_dwordx4 v12, s[16:19], s35 offen nt lds
s_barrier
ds_read_b128 v[24:27], v0 offset:49152
s_waitcnt lgkmcnt(0)
ds_read_b128 v[28:31], v1 offset:49152
s_waitcnt lgkmcnt(0)
v_mfma_f32_16x16x32_bf16 v[192:195], v[24:27], v[64:67], v[192:195]
v_mfma_f32_16x16x32_bf16 v[192:195], v[28:31], v[68:71], v[192:195]
v_mfma_f32_16x16x32_bf16 v[200:203], v[24:27], v[72:75], v[200:203]
v_mfma_f32_16x16x32_bf16 v[200:203], v[28:31], v[76:79], v[200:203]
ds_read_b128 v[32:35], v0 offset:51200
s_waitcnt lgkmcnt(0)
ds_read_b128 v[36:39], v1 offset:51200
s_waitcnt lgkmcnt(0)
v_mfma_f32_16x16x32_bf16 v[196:199], v[32:35], v[64:67], v[196:199]
v_mfma_f32_16x16x32_bf16 v[196:199], v[36:39], v[68:71], v[196:199]
v_mfma_f32_16x16x32_bf16 v[204:207], v[32:35], v[72:75], v[204:207]
v_mfma_f32_16x16x32_bf16 v[204:207], v[36:39], v[76:79], v[204:207]
ds_read_b128 v[40:43], v0 offset:53248
s_waitcnt lgkmcnt(0)
ds_read_b128 v[44:47], v1 offset:53248
s_waitcnt lgkmcnt(0)
v_mfma_f32_16x16x32_bf16 v[208:211], v[40:43], v[64:67], v[208:211]
v_mfma_f32_16x16x32_bf16 v[208:211], v[44:47], v[68:71], v[208:211]
v_mfma_f32_16x16x32_bf16 v[216:219], v[40:43], v[72:75], v[216:219]
v_mfma_f32_16x16x32_bf16 v[216:219], v[44:47], v[76:79], v[216:219]
ds_read_b128 v[24:27], v0 offset:55296
s_waitcnt vmcnt(3)
s_add_u32 m0, s32, 139264
s_xor_b32 s35, s33, 131456
buffer_load_dwordx4 v11, s[12:15], s35 offen nt lds
s_waitcnt lgkmcnt(0)
ds_read_b128 v[28:31], v1 offset:55296
s_waitcnt lgkmcnt(0)
v_mfma_f32_16x16x32_bf16 v[212:215], v[24:27], v[64:67], v[212:215]
v_mfma_f32_16x16x32_bf16 v[212:215], v[28:31], v[68:71], v[212:215]
v_mfma_f32_16x16x32_bf16 v[220:223], v[24:27], v[72:75], v[220:223]
v_mfma_f32_16x16x32_bf16 v[220:223], v[28:31], v[76:79], v[220:223]
ds_read_b128 v[32:35], v0 offset:57344
s_waitcnt lgkmcnt(0)
ds_read_b128 v[36:39], v1 offset:57344
s_waitcnt lgkmcnt(0)
v_mfma_f32_16x16x32_bf16 v[224:227], v[32:35], v[64:67], v[224:227]
v_mfma_f32_16x16x32_bf16 v[224:227], v[36:39], v[68:71], v[224:227]
v_mfma_f32_16x16x32_bf16 v[232:235], v[32:35], v[72:75], v[232:235]
v_mfma_f32_16x16x32_bf16 v[232:235], v[36:39], v[76:79], v[232:235]
ds_read_b128 v[40:43], v0 offset:59392
s_waitcnt vmcnt(3)
s_add_u32 m0, s32, 98304
s_xor_b32 s35, s34, 131456
buffer_load_dwordx4 v12, s[16:19], s35 offen nt lds
s_waitcnt lgkmcnt(0)
ds_read_b128 v[44:47], v1 offset:59392
s_waitcnt lgkmcnt(0)
v_mfma_f32_16x16x32_bf16 v[228:231], v[40:43], v[64:67], v[228:231]
v_mfma_f32_16x16x32_bf16 v[228:231], v[44:47], v[68:71], v[228:231]
v_mfma_f32_16x16x32_bf16 v[236:239], v[40:43], v[72:75], v[236:239]
v_mfma_f32_16x16x32_bf16 v[236:239], v[44:47], v[76:79], v[236:239]
ds_read_b128 v[24:27], v0 offset:61440
s_waitcnt lgkmcnt(0)
ds_read_b128 v[28:31], v1 offset:61440
s_waitcnt lgkmcnt(0)
v_mfma_f32_16x16x32_bf16 v[240:243], v[24:27], v[64:67], v[240:243]
v_mfma_f32_16x16x32_bf16 v[240:243], v[28:31], v[68:71], v[240:243]
v_mfma_f32_16x16x32_bf16 v[248:251], v[24:27], v[72:75], v[248:251]
v_mfma_f32_16x16x32_bf16 v[248:251], v[28:31], v[76:79], v[248:251]
ds_read_b128 v[32:35], v0 offset:63488
ds_read_b128 v[56:59], v8 offset:16384
ds_read_b128 v[60:63], v9 offset:16384
s_waitcnt lgkmcnt(0)
s_waitcnt vmcnt(3)
s_add_u32 m0, s32, 147456
s_xor_b32 s35, s33, 139648
buffer_load_dwordx4 v10, s[12:15], s35 offen nt lds
ds_read_b128 v[36:39], v1 offset:63488
s_waitcnt lgkmcnt(0)
v_mfma_f32_16x16x32_bf16 v[244:247], v[32:35], v[64:67], v[244:247]
v_mfma_f32_16x16x32_bf16 v[244:247], v[36:39], v[68:71], v[244:247]
v_mfma_f32_16x16x32_bf16 v[252:255], v[32:35], v[72:75], v[252:255]
v_mfma_f32_16x16x32_bf16 v[252:255], v[36:39], v[76:79], v[252:255]
s_barrier
ds_read_b128 v[40:43], v2 offset:0
s_waitcnt lgkmcnt(0)
ds_read_b128 v[44:47], v3 offset:0
s_waitcnt lgkmcnt(0)
v_mfma_f32_16x16x32_bf16 v[128:131], v[40:43], v[48:51], v[128:131]
v_mfma_f32_16x16x32_bf16 v[128:131], v[44:47], v[52:55], v[128:131]
v_mfma_f32_16x16x32_bf16 v[136:139], v[40:43], v[56:59], v[136:139]
v_mfma_f32_16x16x32_bf16 v[136:139], v[44:47], v[60:63], v[136:139]
ds_read_b128 v[24:27], v2 offset:2048
s_waitcnt lgkmcnt(0)
ds_read_b128 v[28:31], v3 offset:2048
s_waitcnt lgkmcnt(0)
v_mfma_f32_16x16x32_bf16 v[132:135], v[24:27], v[48:51], v[132:135]
v_mfma_f32_16x16x32_bf16 v[132:135], v[28:31], v[52:55], v[132:135]
v_mfma_f32_16x16x32_bf16 v[140:143], v[24:27], v[56:59], v[140:143]
v_mfma_f32_16x16x32_bf16 v[140:143], v[28:31], v[60:63], v[140:143]
ds_read_b128 v[32:35], v2 offset:4096
s_waitcnt vmcnt(3)
s_add_u32 m0, s32, 106496
s_xor_b32 s35, s34, 164224
buffer_load_dwordx4 v12, s[16:19], s35 offen nt lds
s_waitcnt lgkmcnt(0)
ds_read_b128 v[36:39], v3 offset:4096
s_waitcnt lgkmcnt(0)
v_mfma_f32_16x16x32_bf16 v[144:147], v[32:35], v[48:51], v[144:147]
v_mfma_f32_16x16x32_bf16 v[144:147], v[36:39], v[52:55], v[144:147]
v_mfma_f32_16x16x32_bf16 v[152:155], v[32:35], v[56:59], v[152:155]
v_mfma_f32_16x16x32_bf16 v[152:155], v[36:39], v[60:63], v[152:155]
ds_read_b128 v[40:43], v2 offset:6144
s_waitcnt lgkmcnt(0)
ds_read_b128 v[44:47], v3 offset:6144
s_waitcnt lgkmcnt(0)
v_mfma_f32_16x16x32_bf16 v[148:151], v[40:43], v[48:51], v[148:151]
v_mfma_f32_16x16x32_bf16 v[148:151], v[44:47], v[52:55], v[148:151]
v_mfma_f32_16x16x32_bf16 v[156:159], v[40:43], v[56:59], v[156:159]
v_mfma_f32_16x16x32_bf16 v[156:159], v[44:47], v[60:63], v[156:159]
ds_read_b128 v[24:27], v2 offset:8192
s_waitcnt vmcnt(3)
s_add_u32 m0, s32, 155648
s_xor_b32 s35, s33, 139648
buffer_load_dwordx4 v11, s[12:15], s35 offen nt lds
s_waitcnt lgkmcnt(0)
ds_read_b128 v[28:31], v3 offset:8192
s_waitcnt lgkmcnt(0)
v_mfma_f32_16x16x32_bf16 v[160:163], v[24:27], v[48:51], v[160:163]
v_mfma_f32_16x16x32_bf16 v[160:163], v[28:31], v[52:55], v[160:163]
v_mfma_f32_16x16x32_bf16 v[168:171], v[24:27], v[56:59], v[168:171]
v_mfma_f32_16x16x32_bf16 v[168:171], v[28:31], v[60:63], v[168:171]
ds_read_b128 v[32:35], v2 offset:10240
s_waitcnt lgkmcnt(0)
ds_read_b128 v[36:39], v3 offset:10240
s_waitcnt lgkmcnt(0)
v_mfma_f32_16x16x32_bf16 v[164:167], v[32:35], v[48:51], v[164:167]
v_mfma_f32_16x16x32_bf16 v[164:167], v[36:39], v[52:55], v[164:167]
v_mfma_f32_16x16x32_bf16 v[172:175], v[32:35], v[56:59], v[172:175]
v_mfma_f32_16x16x32_bf16 v[172:175], v[36:39], v[60:63], v[172:175]
ds_read_b128 v[40:43], v2 offset:12288
s_waitcnt vmcnt(3)
s_add_u32 m0, s32, 114688
s_xor_b32 s35, s34, 196992
buffer_load_dwordx4 v12, s[16:19], s35 offen nt lds
s_waitcnt lgkmcnt(0)
ds_read_b128 v[44:47], v3 offset:12288
s_waitcnt lgkmcnt(0)
v_mfma_f32_16x16x32_bf16 v[176:179], v[40:43], v[48:51], v[176:179]
v_mfma_f32_16x16x32_bf16 v[176:179], v[44:47], v[52:55], v[176:179]
v_mfma_f32_16x16x32_bf16 v[184:187], v[40:43], v[56:59], v[184:187]
v_mfma_f32_16x16x32_bf16 v[184:187], v[44:47], v[60:63], v[184:187]
ds_read_b128 v[24:27], v2 offset:14336
s_waitcnt lgkmcnt(0)
ds_read_b128 v[28:31], v3 offset:14336
s_waitcnt lgkmcnt(0)
v_mfma_f32_16x16x32_bf16 v[180:183], v[24:27], v[48:51], v[180:183]
v_mfma_f32_16x16x32_bf16 v[180:183], v[28:31], v[52:55], v[180:183]
v_mfma_f32_16x16x32_bf16 v[188:191], v[24:27], v[56:59], v[188:191]
v_mfma_f32_16x16x32_bf16 v[188:191], v[28:31], v[60:63], v[188:191]
s_barrier
ds_read_b128 v[32:35], v2 offset:16384
s_waitcnt lgkmcnt(0)
ds_read_b128 v[36:39], v3 offset:16384
s_waitcnt lgkmcnt(0)
v_mfma_f32_16x16x32_bf16 v[192:195], v[32:35], v[48:51], v[192:195]
v_mfma_f32_16x16x32_bf16 v[192:195], v[36:39], v[52:55], v[192:195]
v_mfma_f32_16x16x32_bf16 v[200:203], v[32:35], v[56:59], v[200:203]
v_mfma_f32_16x16x32_bf16 v[200:203], v[36:39], v[60:63], v[200:203]
ds_read_b128 v[40:43], v2 offset:18432
s_waitcnt vmcnt(3)
s_add_u32 m0, s32, 122880
s_xor_b32 s35, s34, 229760
buffer_load_dwordx4 v12, s[16:19], s35 offen nt lds
s_waitcnt lgkmcnt(0)
ds_read_b128 v[44:47], v3 offset:18432
s_waitcnt lgkmcnt(0)
v_mfma_f32_16x16x32_bf16 v[196:199], v[40:43], v[48:51], v[196:199]
v_mfma_f32_16x16x32_bf16 v[196:199], v[44:47], v[52:55], v[196:199]
v_mfma_f32_16x16x32_bf16 v[204:207], v[40:43], v[56:59], v[204:207]
v_mfma_f32_16x16x32_bf16 v[204:207], v[44:47], v[60:63], v[204:207]
ds_read_b128 v[24:27], v2 offset:20480
s_waitcnt lgkmcnt(0)
ds_read_b128 v[28:31], v3 offset:20480
s_waitcnt lgkmcnt(0)
v_mfma_f32_16x16x32_bf16 v[208:211], v[24:27], v[48:51], v[208:211]
v_mfma_f32_16x16x32_bf16 v[208:211], v[28:31], v[52:55], v[208:211]
v_mfma_f32_16x16x32_bf16 v[216:219], v[24:27], v[56:59], v[216:219]
v_mfma_f32_16x16x32_bf16 v[216:219], v[28:31], v[60:63], v[216:219]
ds_read_b128 v[32:35], v2 offset:22528
s_waitcnt vmcnt(3)
s_add_u32 m0, s32, 0
s_xor_b32 s35, s36, 131072
buffer_load_dwordx4 v13, s[20:23], s35 offen nt lds
s_waitcnt lgkmcnt(0)
ds_read_b128 v[36:39], v3 offset:22528
s_waitcnt lgkmcnt(0)
v_mfma_f32_16x16x32_bf16 v[212:215], v[32:35], v[48:51], v[212:215]
v_mfma_f32_16x16x32_bf16 v[212:215], v[36:39], v[52:55], v[212:215]
v_mfma_f32_16x16x32_bf16 v[220:223], v[32:35], v[56:59], v[220:223]
v_mfma_f32_16x16x32_bf16 v[220:223], v[36:39], v[60:63], v[220:223]
ds_read_b128 v[40:43], v2 offset:24576
s_waitcnt lgkmcnt(0)
ds_read_b128 v[44:47], v3 offset:24576
s_waitcnt lgkmcnt(0)
v_mfma_f32_16x16x32_bf16 v[224:227], v[40:43], v[48:51], v[224:227]
v_mfma_f32_16x16x32_bf16 v[224:227], v[44:47], v[52:55], v[224:227]
v_mfma_f32_16x16x32_bf16 v[232:235], v[40:43], v[56:59], v[232:235]
v_mfma_f32_16x16x32_bf16 v[232:235], v[44:47], v[60:63], v[232:235]
ds_read_b128 v[24:27], v2 offset:26624
s_waitcnt vmcnt(3)
s_add_u32 m0, s32, 8192
s_xor_b32 s35, s36, 163840
buffer_load_dwordx4 v13, s[20:23], s35 offen nt lds
s_waitcnt lgkmcnt(0)
ds_read_b128 v[28:31], v3 offset:26624
s_waitcnt lgkmcnt(0)
v_mfma_f32_16x16x32_bf16 v[228:231], v[24:27], v[48:51], v[228:231]
v_mfma_f32_16x16x32_bf16 v[228:231], v[28:31], v[52:55], v[228:231]
v_mfma_f32_16x16x32_bf16 v[236:239], v[24:27], v[56:59], v[236:239]
v_mfma_f32_16x16x32_bf16 v[236:239], v[28:31], v[60:63], v[236:239]
ds_read_b128 v[32:35], v2 offset:28672
s_waitcnt lgkmcnt(0)
ds_read_b128 v[36:39], v3 offset:28672
s_waitcnt lgkmcnt(0)
v_mfma_f32_16x16x32_bf16 v[240:243], v[32:35], v[48:51], v[240:243]
v_mfma_f32_16x16x32_bf16 v[240:243], v[36:39], v[52:55], v[240:243]
v_mfma_f32_16x16x32_bf16 v[248:251], v[32:35], v[56:59], v[248:251]
v_mfma_f32_16x16x32_bf16 v[248:251], v[36:39], v[60:63], v[248:251]
ds_read_b128 v[40:43], v2 offset:30720
s_waitcnt lgkmcnt(0)
ds_read_b128 v[44:47], v3 offset:30720
s_waitcnt lgkmcnt(0)
v_mfma_f32_16x16x32_bf16 v[244:247], v[40:43], v[48:51], v[244:247]
v_mfma_f32_16x16x32_bf16 v[244:247], v[44:47], v[52:55], v[244:247]
v_mfma_f32_16x16x32_bf16 v[252:255], v[40:43], v[56:59], v[252:255]
v_mfma_f32_16x16x32_bf16 v[252:255], v[44:47], v[60:63], v[252:255]
ds_read_b128 v[64:67], v8 offset:0
ds_read_b128 v[68:71], v9 offset:0
ds_read_b128 v[72:75], v8 offset:16384
ds_read_b128 v[76:79], v9 offset:16384
s_waitcnt vmcnt(3)
s_add_u32 m0, s32, 16384
s_xor_b32 s35, s36, 196608
buffer_load_dwordx4 v13, s[20:23], s35 offen nt lds
s_barrier
ds_read_b128 v[24:27], v2 offset:32768
s_waitcnt lgkmcnt(0)
ds_read_b128 v[28:31], v3 offset:32768
s_waitcnt lgkmcnt(0)
v_mfma_f32_16x16x32_bf16 v[128:131], v[24:27], v[64:67], v[128:131]
v_mfma_f32_16x16x32_bf16 v[128:131], v[28:31], v[68:71], v[128:131]
v_mfma_f32_16x16x32_bf16 v[136:139], v[24:27], v[72:75], v[136:139]
v_mfma_f32_16x16x32_bf16 v[136:139], v[28:31], v[76:79], v[136:139]
ds_read_b128 v[32:35], v2 offset:34816
s_waitcnt lgkmcnt(0)
ds_read_b128 v[36:39], v3 offset:34816
s_waitcnt lgkmcnt(0)
v_mfma_f32_16x16x32_bf16 v[132:135], v[32:35], v[64:67], v[132:135]
v_mfma_f32_16x16x32_bf16 v[132:135], v[36:39], v[68:71], v[132:135]
v_mfma_f32_16x16x32_bf16 v[140:143], v[32:35], v[72:75], v[140:143]
v_mfma_f32_16x16x32_bf16 v[140:143], v[36:39], v[76:79], v[140:143]
ds_read_b128 v[40:43], v2 offset:36864
s_waitcnt vmcnt(3)
s_add_u32 m0, s32, 24576
s_xor_b32 s35, s36, 229376
buffer_load_dwordx4 v13, s[20:23], s35 offen nt lds
s_waitcnt lgkmcnt(0)
ds_read_b128 v[44:47], v3 offset:36864
s_waitcnt lgkmcnt(0)
v_mfma_f32_16x16x32_bf16 v[144:147], v[40:43], v[64:67], v[144:147]
v_mfma_f32_16x16x32_bf16 v[144:147], v[44:47], v[68:71], v[144:147]
v_mfma_f32_16x16x32_bf16 v[152:155], v[40:43], v[72:75], v[152:155]
v_mfma_f32_16x16x32_bf16 v[152:155], v[44:47], v[76:79], v[152:155]
ds_read_b128 v[24:27], v2 offset:38912
v_max_f32 v16, v128, v129
v_max_f32 v17, v136, v137
s_waitcnt lgkmcnt(0)
ds_read_b128 v[28:31], v3 offset:38912
s_waitcnt lgkmcnt(0)
v_mfma_f32_16x16x32_bf16 v[148:151], v[24:27], v[64:67], v[148:151]
v_mfma_f32_16x16x32_bf16 v[148:151], v[28:31], v[68:71], v[148:151]
v_max3_f32 v16, v16, v130, v131
v_max3_f32 v17, v17, v138, v139
v_mfma_f32_16x16x32_bf16 v[156:159], v[24:27], v[72:75], v[156:159]
v_mfma_f32_16x16x32_bf16 v[156:159], v[28:31], v[76:79], v[156:159]
ds_read_b128 v[32:35], v2 offset:40960
v_max3_f32 v16, v16, v132, v133
v_max3_f32 v17, v17, v140, v141
s_waitcnt vmcnt(2)
s_add_u32 m0, s32, 32768
s_xor_b32 s35, s36, 131200
buffer_load_dwordx4 v13, s[20:23], s35 offen nt lds
s_waitcnt lgkmcnt(0)
ds_read_b128 v[36:39], v3 offset:40960
s_waitcnt lgkmcnt(0)
v_mfma_f32_16x16x32_bf16 v[160:163], v[32:35], v[64:67], v[160:163]
v_mfma_f32_16x16x32_bf16 v[160:163], v[36:39], v[68:71], v[160:163]
v_max3_f32 v16, v16, v134, v135
v_max3_f32 v17, v17, v142, v143
v_mfma_f32_16x16x32_bf16 v[168:171], v[32:35], v[72:75], v[168:171]
v_mfma_f32_16x16x32_bf16 v[168:171], v[36:39], v[76:79], v[168:171]
ds_read_b128 v[40:43], v2 offset:43008
v_max3_f32 v16, v16, v144, v145
v_max3_f32 v17, v17, v152, v153
s_waitcnt lgkmcnt(0)
ds_read_b128 v[44:47], v3 offset:43008
s_waitcnt lgkmcnt(0)
v_mfma_f32_16x16x32_bf16 v[164:167], v[40:43], v[64:67], v[164:167]
v_mfma_f32_16x16x32_bf16 v[164:167], v[44:47], v[68:71], v[164:167]
v_max3_f32 v16, v16, v146, v147
v_max3_f32 v17, v17, v154, v155
v_mfma_f32_16x16x32_bf16 v[172:175], v[40:43], v[72:75], v[172:175]
v_mfma_f32_16x16x32_bf16 v[172:175], v[44:47], v[76:79], v[172:175]
ds_read_b128 v[24:27], v2 offset:45056
v_max3_f32 v16, v16, v148, v149
v_max3_f32 v17, v17, v156, v157
s_waitcnt vmcnt(2)
s_add_u32 m0, s32, 40960
s_xor_b32 s35, s36, 163968
buffer_load_dwordx4 v13, s[20:23], s35 offen nt lds
s_waitcnt lgkmcnt(0)
ds_read_b128 v[28:31], v3 offset:45056
s_waitcnt lgkmcnt(0)
v_mfma_f32_16x16x32_bf16 v[176:179], v[24:27], v[64:67], v[176:179]
v_mfma_f32_16x16x32_bf16 v[176:179], v[28:31], v[68:71], v[176:179]
v_max3_f32 v16, v16, v150, v151
v_max3_f32 v17, v17, v158, v159
v_mfma_f32_16x16x32_bf16 v[184:187], v[24:27], v[72:75], v[184:187]
v_mfma_f32_16x16x32_bf16 v[184:187], v[28:31], v[76:79], v[184:187]
ds_read_b128 v[32:35], v2 offset:47104
v_max3_f32 v16, v16, v160, v161
v_max3_f32 v17, v17, v168, v169
s_waitcnt lgkmcnt(0)
ds_read_b128 v[36:39], v3 offset:47104
s_waitcnt lgkmcnt(0)
v_mfma_f32_16x16x32_bf16 v[180:183], v[32:35], v[64:67], v[180:183]
v_mfma_f32_16x16x32_bf16 v[180:183], v[36:39], v[68:71], v[180:183]
v_max3_f32 v16, v16, v162, v163
v_max3_f32 v17, v17, v170, v171
v_mfma_f32_16x16x32_bf16 v[188:191], v[32:35], v[72:75], v[188:191]
v_mfma_f32_16x16x32_bf16 v[188:191], v[36:39], v[76:79], v[188:191]
v_max3_f32 v16, v16, v164, v165
v_max3_f32 v17, v17, v172, v173
s_barrier
ds_read_b128 v[40:43], v2 offset:49152
s_waitcnt lgkmcnt(0)
ds_read_b128 v[44:47], v3 offset:49152
s_waitcnt lgkmcnt(0)
v_mfma_f32_16x16x32_bf16 v[192:195], v[40:43], v[64:67], v[192:195]
v_mfma_f32_16x16x32_bf16 v[192:195], v[44:47], v[68:71], v[192:195]
v_max3_f32 v16, v16, v166, v167
v_max3_f32 v17, v17, v174, v175
v_mfma_f32_16x16x32_bf16 v[200:203], v[40:43], v[72:75], v[200:203]
v_mfma_f32_16x16x32_bf16 v[200:203], v[44:47], v[76:79], v[200:203]
ds_read_b128 v[24:27], v2 offset:51200
v_max3_f32 v16, v16, v176, v177
v_max3_f32 v17, v17, v184, v185
s_waitcnt vmcnt(2)
s_add_u32 m0, s32, 49152
s_xor_b32 s35, s36, 196736
buffer_load_dwordx4 v13, s[20:23], s35 offen nt lds
s_waitcnt lgkmcnt(0)
ds_read_b128 v[28:31], v3 offset:51200
s_waitcnt lgkmcnt(0)
v_mfma_f32_16x16x32_bf16 v[196:199], v[24:27], v[64:67], v[196:199]
v_mfma_f32_16x16x32_bf16 v[196:199], v[28:31], v[68:71], v[196:199]
v_max3_f32 v16, v16, v178, v179
v_max3_f32 v17, v17, v186, v187
v_mfma_f32_16x16x32_bf16 v[204:207], v[24:27], v[72:75], v[204:207]
v_mfma_f32_16x16x32_bf16 v[204:207], v[28:31], v[76:79], v[204:207]
ds_read_b128 v[32:35], v2 offset:53248
v_max3_f32 v16, v16, v180, v181
v_max3_f32 v17, v17, v188, v189
s_waitcnt lgkmcnt(0)
ds_read_b128 v[36:39], v3 offset:53248
s_waitcnt lgkmcnt(0)
v_mfma_f32_16x16x32_bf16 v[208:211], v[32:35], v[64:67], v[208:211]
v_mfma_f32_16x16x32_bf16 v[208:211], v[36:39], v[68:71], v[208:211]
v_max3_f32 v16, v16, v182, v183
v_max3_f32 v17, v17, v190, v191
v_mfma_f32_16x16x32_bf16 v[216:219], v[32:35], v[72:75], v[216:219]
v_mfma_f32_16x16x32_bf16 v[216:219], v[36:39], v[76:79], v[216:219]
ds_read_b128 v[40:43], v2 offset:55296
v_max3_f32 v16, v16, v192, v193
v_max3_f32 v17, v17, v200, v201
s_waitcnt vmcnt(2)
s_add_u32 m0, s32, 57344
s_xor_b32 s35, s36, 229504
buffer_load_dwordx4 v13, s[20:23], s35 offen nt lds
s_waitcnt lgkmcnt(0)
ds_read_b128 v[44:47], v3 offset:55296
s_waitcnt lgkmcnt(0)
v_mfma_f32_16x16x32_bf16 v[212:215], v[40:43], v[64:67], v[212:215]
v_mfma_f32_16x16x32_bf16 v[212:215], v[44:47], v[68:71], v[212:215]
v_max3_f32 v16, v16, v194, v195
v_max3_f32 v17, v17, v202, v203
v_mfma_f32_16x16x32_bf16 v[220:223], v[40:43], v[72:75], v[220:223]
v_mfma_f32_16x16x32_bf16 v[220:223], v[44:47], v[76:79], v[220:223]
ds_read_b128 v[24:27], v2 offset:57344
v_max3_f32 v16, v16, v196, v197
v_max3_f32 v17, v17, v204, v205
s_waitcnt lgkmcnt(0)
ds_read_b128 v[28:31], v3 offset:57344
s_waitcnt lgkmcnt(0)
v_mfma_f32_16x16x32_bf16 v[224:227], v[24:27], v[64:67], v[224:227]
v_mfma_f32_16x16x32_bf16 v[224:227], v[28:31], v[68:71], v[224:227]
v_max3_f32 v16, v16, v198, v199
v_max3_f32 v17, v17, v206, v207
v_mfma_f32_16x16x32_bf16 v[232:235], v[24:27], v[72:75], v[232:235]
v_mfma_f32_16x16x32_bf16 v[232:235], v[28:31], v[76:79], v[232:235]
ds_read_b128 v[32:35], v2 offset:59392
v_max3_f32 v16, v16, v208, v209
v_max3_f32 v17, v17, v216, v217
s_waitcnt vmcnt(2)
s_add_u32 m0, s32, 65536
s_xor_b32 s35, s36, 131328
buffer_load_dwordx4 v13, s[20:23], s35 offen nt lds
s_waitcnt lgkmcnt(0)
ds_read_b128 v[36:39], v3 offset:59392
s_waitcnt lgkmcnt(0)
v_mfma_f32_16x16x32_bf16 v[228:231], v[32:35], v[64:67], v[228:231]
v_mfma_f32_16x16x32_bf16 v[228:231], v[36:39], v[68:71], v[228:231]
v_max3_f32 v16, v16, v210, v211
v_max3_f32 v17, v17, v218, v219
v_mfma_f32_16x16x32_bf16 v[236:239], v[32:35], v[72:75], v[236:239]
v_mfma_f32_16x16x32_bf16 v[236:239], v[36:39], v[76:79], v[236:239]
ds_read_b128 v[40:43], v2 offset:61440
v_max3_f32 v16, v16, v212, v213
v_max3_f32 v17, v17, v220, v221
s_waitcnt lgkmcnt(0)
ds_read_b128 v[44:47], v3 offset:61440
s_waitcnt lgkmcnt(0)
v_mfma_f32_16x16x32_bf16 v[240:243], v[40:43], v[64:67], v[240:243]
v_mfma_f32_16x16x32_bf16 v[240:243], v[44:47], v[68:71], v[240:243]
v_max3_f32 v16, v16, v214, v215
v_max3_f32 v17, v17, v222, v223
v_mfma_f32_16x16x32_bf16 v[248:251], v[40:43], v[72:75], v[248:251]
v_mfma_f32_16x16x32_bf16 v[248:251], v[44:47], v[76:79], v[248:251]
ds_read_b128 v[24:27], v2 offset:63488
v_max3_f32 v16, v16, v224, v225
v_max3_f32 v17, v17, v232, v233
s_waitcnt vmcnt(2)
s_add_u32 m0, s32, 73728
s_xor_b32 s35, s36, 164096
buffer_load_dwordx4 v13, s[20:23], s35 offen nt lds
s_waitcnt lgkmcnt(0)
ds_read_b128 v[28:31], v3 offset:63488
s_waitcnt lgkmcnt(0)
v_mfma_f32_16x16x32_bf16 v[244:247], v[24:27], v[64:67], v[244:247]
v_mfma_f32_16x16x32_bf16 v[244:247], v[28:31], v[68:71], v[244:247]
v_max3_f32 v16, v16, v226, v227
v_max3_f32 v17, v17, v234, v235
v_mfma_f32_16x16x32_bf16 v[252:255], v[24:27], v[72:75], v[252:255]
v_mfma_f32_16x16x32_bf16 v[252:255], v[28:31], v[76:79], v[252:255]
v_max3_f32 v16, v16, v228, v229
v_max3_f32 v17, v17, v236, v237
v_max3_f32 v16, v16, v230, v231
v_max3_f32 v17, v17, v238, v239
s_branch L_qb_join
L_qb1:
s_waitcnt vmcnt(18)
s_barrier
ds_read_b128 v[24:27], v0 offset:0
s_waitcnt lgkmcnt(0)
ds_read_b128 v[28:31], v1 offset:0
s_waitcnt lgkmcnt(0)
v_mfma_f32_16x16x32_bf16 v[128:131], v[24:27], v[48:51], 0
v_mfma_f32_16x16x32_bf16 v[128:131], v[28:31], v[52:55], v[128:131]
v_mul_f32 v192, v18, v192
v_mul_f32 v193, v18, v193
v_mul_f32 v194, v18, v194
v_mul_f32 v195, v18, v195
v_mul_f32 v196, v18, v196
v_mul_f32 v197, v18, v197
v_mul_f32 v198, v18, v198
v_mul_f32 v199, v18, v199
v_mfma_f32_16x16x32_bf16 v[136:139], v[24:27], v[56:59], 0
v_mfma_f32_16x16x32_bf16 v[136:139], v[28:31], v[60:63], v[136:139]
ds_read_b128 v[32:35], v0 offset:2048
v_cvt_pk_bf16_f32 v192, v192, v193
v_cvt_pk_bf16_f32 v193, v194, v195
v_cvt_pk_bf16_f32 v194, v196, v197
v_cvt_pk_bf16_f32 v195, v198, v199
v_mul_f32 v200, v18, v200
v_mul_f32 v201, v18, v201
v_permlane16_swap_b32 v192, v194
s_waitcnt lgkmcnt(0)
ds_read_b128 v[36:39], v1 offset:2048
s_waitcnt lgkmcnt(0)
v_mfma_f32_16x16x32_bf16 v[132:135], v[32:35], v[48:51], 0
v_mfma_f32_16x16x32_bf16 v[132:135], v[36:39], v[52:55], v[132:135]
v_mul_f32 v202, v18, v202
v_mul_f32 v203, v18, v203
v_mul_f32 v204, v18, v204
v_mul_f32 v205, v18, v205
v_mul_f32 v206, v18, v206
v_permlane16_swap_b32 v193, v195
v_mul_f32 v207, v18, v207
v_mfma_f32_16x16x32_bf16 v[140:143], v[32:35], v[56:59], 0
v_mfma_f32_16x16x32_bf16 v[140:143], v[36:39], v[60:63], v[140:143]
ds_read_b128 v[40:43], v0 offset:4096
v_cvt_pk_bf16_f32 v196, v200, v201
v_cvt_pk_bf16_f32 v197, v202, v203
v_cvt_pk_bf16_f32 v198, v204, v205
v_cvt_pk_bf16_f32 v199, v206, v207
v_mul_f32 v208, v20, v208
v_mul_f32 v209, v20, v209
v_permlane16_swap_b32 v196, v198
s_waitcnt lgkmcnt(0)
ds_read_b128 v[44:47], v1 offset:4096
s_waitcnt lgkmcnt(0)
v_mfma_f32_16x16x32_bf16 v[144:147], v[40:43], v[48:51], 0
v_mfma_f32_16x16x32_bf16 v[144:147], v[44:47], v[52:55], v[144:147]
v_mul_f32 v210, v20, v210
v_permlane16_swap_b32 v197, v199
v_mul_f32 v211, v20, v211
v_mul_f32 v212, v20, v212
s_mov_b64 vcc, s[62:63]
v_cndmask_b32_dpp v112, v196, v192, vcc quad_perm:[1,0,3,2] row_mask:0xf bank_mask:0xf
v_mul_f32 v213, v20, v213
v_cndmask_b32_dpp v114, v198, v194, vcc quad_perm:[1,0,3,2] row_mask:0xf bank_mask:0xf
v_mfma_f32_16x16x32_bf16 v[152:155], v[40:43], v[56:59], 0
v_mfma_f32_16x16x32_bf16 v[152:155], v[44:47], v[60:63], v[152:155]
ds_read_b128 v[24:27], v0 offset:6144
v_mul_f32 v214, v20, v214
v_cndmask_b32_dpp v113, v197, v193, vcc quad_perm:[1,0,3,2] row_mask:0xf bank_mask:0xf
v_mul_f32 v215, v20, v215
v_cndmask_b32_dpp v115, v199, v195, vcc quad_perm:[1,0,3,2] row_mask:0xf bank_mask:0xf
v_cvt_pk_bf16_f32 v208, v208, v209
v_cvt_pk_bf16_f32 v209, v210, v211
v_cvt_pk_bf16_f32 v210, v212, v213
v_cvt_pk_bf16_f32 v211, v214, v215
s_waitcnt vmcnt(7)
ds_read_b128 v[64:67], v8 offset:0
ds_read_b128 v[68:71], v9 offset:0
s_waitcnt lgkmcnt(0)
s_waitcnt vmcnt(2)
s_add_u32 m0, s32, 131072
s_xor_b32 s35, s33, 131328
buffer_load_dwordx4 v10, s[12:15], s35 offen nt lds
ds_read_b128 v[28:31], v1 offset:6144
s_waitcnt lgkmcnt(0)
v_mfma_f32_16x16x32_bf16 v[148:151], v[24:27], v[48:51], 0
v_mfma_f32_16x16x32_bf16 v[148:151], v[28:31], v[52:55], v[148:151]
v_mul_f32 v216, v20, v216
s_not_b64 vcc, vcc
v_cndmask_b32_dpp v116, v192, v196, vcc quad_perm:[1,0,3,2] row_mask:0xf bank_mask:0xf
v_mul_f32 v217, v20, v217
v_cndmask_b32_dpp v118, v194, v198, vcc quad_perm:[1,0,3,2] row_mask:0xf bank_mask:0xf
v_mul_f32 v218, v20, v218
v_cndmask_b32_dpp v117, v193, v197, vcc quad_perm:[1,0,3,2] row_mask:0xf bank_mask:0xf
v_mul_f32 v219, v20, v219
v_cndmask_b32_dpp v119, v195, v199, vcc quad_perm:[1,0,3,2] row_mask:0xf bank_mask:0xf
v_mfma_f32_16x16x32_bf16 v[156:159], v[24:27], v[56:59], 0
v_mfma_f32_16x16x32_bf16 v[156:159], v[28:31], v[60:63], v[156:159]
ds_read_b128 v[32:35], v0 offset:8192
v_mul_f32 v220, v20, v220
v_permlane16_swap_b32 v208, v210
v_mul_f32 v221, v20, v221
v_permlane16_swap_b32 v209, v211
v_mul_f32 v222, v20, v222
v_mul_f32 v223, v20, v223
s_waitcnt lgkmcnt(0)
ds_read_b128 v[36:39], v1 offset:8192
s_waitcnt lgkmcnt(0)
v_mfma_f32_16x16x32_bf16 v[160:163], v[32:35], v[48:51], 0
v_mfma_f32_16x16x32_bf16 v[160:163], v[36:39], v[52:55], v[160:163]
v_cvt_pk_bf16_f32 v212, v216, v217
v_cvt_pk_bf16_f32 v213, v218, v219
v_cvt_pk_bf16_f32 v214, v220, v221
v_cvt_pk_bf16_f32 v215, v222, v223
s_nop 0
v_permlane16_swap_b32 v212, v214
v_permlane16_swap_b32 v213, v215
v_mfma_f32_16x16x32_bf16 v[168:171], v[32:35], v[56:59], 0
v_mfma_f32_16x16x32_bf16 v[168:171], v[36:39], v[60:63], v[168:171]
ds_read_b128 v[40:43], v0 offset:10240
s_not_b64 vcc, vcc
s_nop 0
v_cndmask_b32_dpp v120, v212, v208, vcc quad_perm:[1,0,3,2] row_mask:0xf bank_mask:0xf
v_cndmask_b32_dpp v122, v214, v210, vcc quad_perm:[1,0,3,2] row_mask:0xf bank_mask:0xf
v_cndmask_b32_dpp v121, v213, v209, vcc quad_perm:[1,0,3,2] row_mask:0xf bank_mask:0xf
v_cndmask_b32_dpp v123, v215, v211, vcc quad_perm:[1,0,3,2] row_mask:0xf bank_mask:0xf
s_not_b64 vcc, vcc
v_cndmask_b32_dpp v124, v208, v212, vcc quad_perm:[1,0,3,2] row_mask:0xf bank_mask:0xf
v_cndmask_b32_dpp v126, v210, v214, vcc quad_perm:[1,0,3,2] row_mask:0xf bank_mask:0xf
v_cndmask_b32_dpp v125, v209, v213, vcc quad_perm:[1,0,3,2] row_mask:0xf bank_mask:0xf
v_cndmask_b32_dpp v127, v211, v215, vcc quad_perm:[1,0,3,2] row_mask:0xf bank_mask:0xf
s_waitcnt lgkmcnt(0)
ds_read_b128 v[44:47], v1 offset:10240
s_waitcnt lgkmcnt(0)
v_mfma_f32_16x16x32_bf16 v[164:167], v[40:43], v[48:51], 0
v_mfma_f32_16x16x32_bf16 v[164:167], v[44:47], v[52:55], v[164:167]
v_mfma_f32_16x16x32_bf16 v[172:175], v[40:43], v[56:59], 0
v_mfma_f32_16x16x32_bf16 v[172:175], v[44:47], v[60:63], v[172:175]
ds_read_b128 v[24:27], v0 offset:12288
s_waitcnt vmcnt(2)
s_add_u32 m0, s32, 139264
s_xor_b32 s35, s33, 131328
buffer_load_dwordx4 v11, s[12:15], s35 offen nt lds
s_waitcnt lgkmcnt(0)
ds_read_b128 v[28:31], v1 offset:12288
s_waitcnt lgkmcnt(0)
v_mfma_f32_16x16x32_bf16 v[176:179], v[24:27], v[48:51], 0
v_mfma_f32_16x16x32_bf16 v[176:179], v[28:31], v[52:55], v[176:179]
v_mfma_f32_16x16x32_bf16 v[184:187], v[24:27], v[56:59], 0
v_mfma_f32_16x16x32_bf16 v[184:187], v[28:31], v[60:63], v[184:187]
ds_read_b128 v[32:35], v0 offset:14336
s_waitcnt lgkmcnt(0)
ds_read_b128 v[36:39], v1 offset:14336
s_waitcnt lgkmcnt(0)
v_mfma_f32_16x16x32_bf16 v[180:183], v[32:35], v[48:51], 0
v_mfma_f32_16x16x32_bf16 v[180:183], v[36:39], v[52:55], v[180:183]
v_mfma_f32_16x16x32_bf16 v[188:191], v[32:35], v[56:59], 0
v_mfma_f32_16x16x32_bf16 v[188:191], v[36:39], v[60:63], v[188:191]
s_barrier
ds_read_b128 v[40:43], v0 offset:16384
s_waitcnt lgkmcnt(0)
ds_read_b128 v[44:47], v1 offset:16384
s_waitcnt lgkmcnt(0)
v_mfma_f32_16x16x32_bf16 v[192:195], v[40:43], v[48:51], 0
v_mfma_f32_16x16x32_bf16 v[192:195], v[44:47], v[52:55], v[192:195]
v_mfma_f32_16x16x32_bf16 v[200:203], v[40:43], v[56:59], 0
v_mfma_f32_16x16x32_bf16 v[200:203], v[44:47], v[60:63], v[200:203]
ds_read_b128 v[24:27], v0 offset:18432
s_waitcnt vmcnt(2)
s_add_u32 m0, s32, 65536
s_xor_b32 s35, s34, 131328
buffer_load_dwordx4 v12, s[16:19], s35 offen nt lds
s_waitcnt lgkmcnt(0)
ds_read_b128 v[28:31], v1 offset:18432
s_waitcnt lgkmcnt(0)
v_mfma_f32_16x16x32_bf16 v[196:199], v[24:27], v[48:51], 0
v_mfma_f32_16x16x32_bf16 v[196:199], v[28:31], v[52:55], v[196:199]
v_mfma_f32_16x16x32_bf16 v[204:207], v[24:27], v[56:59], 0
v_mfma_f32_16x16x32_bf16 v[204:207], v[28:31], v[60:63], v[204:207]
ds_read_b128 v[32:35], v0 offset:20480
s_waitcnt lgkmcnt(0)
ds_read_b128 v[36:39], v1 offset:20480
s_waitcnt lgkmcnt(0)
v_mfma_f32_16x16x32_bf16 v[208:211], v[32:35], v[48:51], 0
v_mfma_f32_16x16x32_bf16 v[208:211], v[36:39], v[52:55], v[208:211]
v_mfma_f32_16x16x32_bf16 v[216:219], v[32:35], v[56:59], 0
v_mfma_f32_16x16x32_bf16 v[216:219], v[36:39], v[60:63], v[216:219]
ds_read_b128 v[40:43], v0 offset:22528
s_waitcnt lgkmcnt(0)
ds_read_b128 v[44:47], v1 offset:22528
s_waitcnt lgkmcnt(0)
v_mfma_f32_16x16x32_bf16 v[212:215], v[40:43], v[48:51], 0
v_mfma_f32_16x16x32_bf16 v[212:215], v[44:47], v[52:55], v[212:215]
v_mfma_f32_16x16x32_bf16 v[220:223], v[40:43], v[56:59], 0
v_mfma_f32_16x16x32_bf16 v[220:223], v[44:47], v[60:63], v[220:223]
ds_read_b128 v[24:27], v0 offset:24576
ds_read_b128 v[72:75], v8 offset:16384
ds_read_b128 v[76:79], v9 offset:16384
s_waitcnt lgkmcnt(0)
s_waitcnt vmcnt(2)
s_add_u32 m0, s32, 147456
s_xor_b32 s35, s33, 139520
buffer_load_dwordx4 v10, s[12:15], s35 offen nt lds
ds_read_b128 v[28:31], v1 offset:24576
s_waitcnt lgkmcnt(0)
v_mfma_f32_16x16x32_bf16 v[224:227], v[24:27], v[48:51], 0
v_mfma_f32_16x16x32_bf16 v[224:227], v[28:31], v[52:55], v[224:227]
v_mfma_f32_16x16x32_bf16 v[232:235], v[24:27], v[56:59], 0
v_mfma_f32_16x16x32_bf16 v[232:235], v[28:31], v[60:63], v[232:235]
ds_read_b128 v[32:35], v0 offset:26624
s_waitcnt lgkmcnt(0)
ds_read_b128 v[36:39], v1 offset:26624
s_waitcnt lgkmcnt(0)
v_mfma_f32_16x16x32_bf16 v[228:231], v[32:35], v[48:51], 0
v_mfma_f32_16x16x32_bf16 v[228:231], v[36:39], v[52:55], v[228:231]
v_mfma_f32_16x16x32_bf16 v[236:239], v[32:35], v[56:59], 0
v_mfma_f32_16x16x32_bf16 v[236:239], v[36:39], v[60:63], v[236:239]
ds_read_b128 v[40:43], v0 offset:28672
s_waitcnt vmcnt(2)
s_add_u32 m0, s32, 73728
s_xor_b32 s35, s34, 164096
buffer_load_dwordx4 v12, s[16:19], s35 offen nt lds
s_waitcnt lgkmcnt(0)
ds_read_b128 v[44:47], v1 offset:28672
s_waitcnt lgkmcnt(0)
v_mfma_f32_16x16x32_bf16 v[240:243], v[40:43], v[48:51], 0
v_mfma_f32_16x16x32_bf16 v[240:243], v[44:47], v[52:55], v[240:243]
v_mfma_f32_16x16x32_bf16 v[248:251], v[40:43], v[56:59], 0
v_mfma_f32_16x16x32_bf16 v[248:251], v[44:47], v[60:63], v[248:251]
ds_read_b128 v[24:27], v0 offset:30720
s_waitcnt lgkmcnt(0)
ds_read_b128 v[28:31], v1 offset:30720
s_waitcnt lgkmcnt(0)
v_mfma_f32_16x16x32_bf16 v[244:247], v[24:27], v[48:51], 0
v_mfma_f32_16x16x32_bf16 v[244:247], v[28:31], v[52:55], v[244:247]
v_mfma_f32_16x16x32_bf16 v[252:255], v[24:27], v[56:59], 0
v_mfma_f32_16x16x32_bf16 v[252:255], v[28:31], v[60:63], v[252:255]
s_barrier
ds_read_b128 v[32:35], v0 offset:32768
s_waitcnt lgkmcnt(0)
ds_read_b128 v[36:39], v1 offset:32768
s_waitcnt lgkmcnt(0)
v_mfma_f32_16x16x32_bf16 v[128:131], v[32:35], v[64:67], v[128:131]
v_mfma_f32_16x16x32_bf16 v[128:131], v[36:39], v[68:71], v[128:131]
v_mfma_f32_16x16x32_bf16 v[136:139], v[32:35], v[72:75], v[136:139]
v_mfma_f32_16x16x32_bf16 v[136:139], v[36:39], v[76:79], v[136:139]
ds_read_b128 v[40:43], v0 offset:34816
s_waitcnt vmcnt(2)
s_add_u32 m0, s32, 155648
s_xor_b32 s35, s33, 139520
buffer_load_dwordx4 v11, s[12:15], s35 offen nt lds
s_waitcnt lgkmcnt(0)
ds_read_b128 v[44:47], v1 offset:34816
s_waitcnt lgkmcnt(0)
v_mfma_f32_16x16x32_bf16 v[132:135], v[40:43], v[64:67], v[132:135]
v_mfma_f32_16x16x32_bf16 v[132:135], v[44:47], v[68:71], v[132:135]
v_mfma_f32_16x16x32_bf16 v[140:143], v[40:43], v[72:75], v[140:143]
v_mfma_f32_16x16x32_bf16 v[140:143], v[44:47], v[76:79], v[140:143]
ds_read_b128 v[24:27], v0 offset:36864
s_waitcnt lgkmcnt(0)
ds_read_b128 v[28:31], v1 offset:36864
s_waitcnt lgkmcnt(0)
v_mfma_f32_16x16x32_bf16 v[144:147], v[24:27], v[64:67], v[144:147]
v_mfma_f32_16x16x32_bf16 v[144:147], v[28:31], v[68:71], v[144:147]
v_mfma_f32_16x16x32_bf16 v[152:155], v[24:27], v[72:75], v[152:155]
v_mfma_f32_16x16x32_bf16 v[152:155], v[28:31], v[76:79], v[152:155]
ds_read_b128 v[32:35], v0 offset:38912
s_waitcnt vmcnt(2)
s_add_u32 m0, s32, 81920
s_xor_b32 s35, s34, 196864
buffer_load_dwordx4 v12, s[16:19], s35 offen nt lds
s_waitcnt lgkmcnt(0)
ds_read_b128 v[36:39], v1 offset:38912
s_waitcnt lgkmcnt(0)
v_mfma_f32_16x16x32_bf16 v[148:151], v[32:35], v[64:67], v[148:151]
v_mfma_f32_16x16x32_bf16 v[148:151], v[36:39], v[68:71], v[148:151]
v_mfma_f32_16x16x32_bf16 v[156:159], v[32:35], v[72:75], v[156:159]
v_mfma_f32_16x16x32_bf16 v[156:159], v[36:39], v[76:79], v[156:159]
ds_read_b128 v[40:43], v0 offset:40960
s_waitcnt lgkmcnt(0)
ds_read_b128 v[44:47], v1 offset:40960
s_waitcnt lgkmcnt(0)
v_mfma_f32_16x16x32_bf16 v[160:163], v[40:43], v[64:67], v[160:163]
v_mfma_f32_16x16x32_bf16 v[160:163], v[44:47], v[68:71], v[160:163]
v_mfma_f32_16x16x32_bf16 v[168:171], v[40:43], v[72:75], v[168:171]
v_mfma_f32_16x16x32_bf16 v[168:171], v[44:47], v[76:79], v[168:171]
ds_read_b128 v[24:27], v0 offset:43008
s_waitcnt lgkmcnt(0)
ds_read_b128 v[28:31], v1 offset:43008
s_waitcnt lgkmcnt(0)
v_mfma_f32_16x16x32_bf16 v[164:167], v[24:27], v[64:67], v[164:167]
v_mfma_f32_16x16x32_bf16 v[164:167], v[28:31], v[68:71], v[164:167]
v_mfma_f32_16x16x32_bf16 v[172:175], v[24:27], v[72:75], v[172:175]
v_mfma_f32_16x16x32_bf16 v[172:175], v[28:31], v[76:79], v[172:175]
ds_read_b128 v[32:35], v0 offset:45056
ds_read_b128 v[48:51], v8 offset:0
ds_read_b128 v[52:55], v9 offset:0
s_waitcnt lgkmcnt(0)
s_waitcnt vmcnt(2)
s_add_u32 m0, s32, 131072
s_xor_b32 s35, s33, 131456
buffer_load_dwordx4 v10, s[12:15], s35 offen nt lds
ds_read_b128 v[36:39], v1 offset:45056
s_waitcnt lgkmcnt(0)
v_mfma_f32_16x16x32_bf16 v[176:179], v[32:35], v[64:67], v[176:179]
v_mfma_f32_16x16x32_bf16 v[176:179], v[36:39], v[68:71], v[176:179]
v_mfma_f32_16x16x32_bf16 v[184:187], v[32:35], v[72:75], v[184:187]
v_mfma_f32_16x16x32_bf16 v[184:187], v[36:39], v[76:79], v[184:187]
ds_read_b128 v[40:43], v0 offset:47104
s_waitcnt lgkmcnt(0)
ds_read_b128 v[44:47], v1 offset:47104
s_waitcnt lgkmcnt(0)
v_mfma_f32_16x16x32_bf16 v[180:183], v[40:43], v[64:67], v[180:183]
v_mfma_f32_16x16x32_bf16 v[180:183], v[44:47], v[68:71], v[180:183]
v_mfma_f32_16x16x32_bf16 v[188:191], v[40:43], v[72:75], v[188:191]
v_mfma_f32_16x16x32_bf16 v[188:191], v[44:47], v[76:79], v[188:191]
s_waitcnt vmcnt(2)
s_add_u32 m0, s32, 90112
s_xor_b32 s35, s34, 229632
buffer_load_dwordx4 v12, s[16:19], s35 offen nt lds
s_barrier
ds_read_b128 v[24:27], v0 offset:49152
s_waitcnt lgkmcnt(0)
ds_read_b128 v[28:31], v1 offset:49152
s_waitcnt lgkmcnt(0)
v_mfma_f32_16x16x32_bf16 v[192:195], v[24:27], v[64:67], v[192:195]
v_mfma_f32_16x16x32_bf16 v[192:195], v[28:31], v[68:71], v[192:195]
v_mfma_f32_16x16x32_bf16 v[200:203], v[24:27], v[72:75], v[200:203]
v_mfma_f32_16x16x32_bf16 v[200:203], v[28:31], v[76:79], v[200:203]
ds_read_b128 v[32:35], v0 offset:51200
s_waitcnt lgkmcnt(0)
ds_read_b128 v[36:39], v1 offset:51200
s_waitcnt lgkmcnt(0)
v_mfma_f32_16x16x32_bf16 v[196:199], v[32:35], v[64:67], v[196:199]
v_mfma_f32_16x16x32_bf16 v[196:199], v[36:39], v[68:71], v[196:199]
v_mfma_f32_16x16x32_bf16 v[204:207], v[32:35], v[72:75], v[204:207]
v_mfma_f32_16x16x32_bf16 v[204:207], v[36:39], v[76:79], v[204:207]
ds_read_b128 v[40:43], v0 offset:53248
s_waitcnt lgkmcnt(0)
ds_read_b128 v[44:47], v1 offset:53248
s_waitcnt lgkmcnt(0)
v_mfma_f32_16x16x32_bf16 v[208:211], v[40:43], v[64:67], v[208:211]
v_mfma_f32_16x16x32_bf16 v[208:211], v[44:47], v[68:71], v[208:211]
v_mfma_f32_16x16x32_bf16 v[216:219], v[40:43], v[72:75], v[216:219]
v_mfma_f32_16x16x32_bf16 v[216:219], v[44:47], v[76:79], v[216:219]
ds_read_b128 v[24:27], v0 offset:55296
s_waitcnt vmcnt(2)
s_add_u32 m0, s32, 139264
s_xor_b32 s35, s33, 131456
buffer_load_dwordx4 v11, s[12:15], s35 offen nt lds
s_waitcnt lgkmcnt(0)
ds_read_b128 v[28:31], v1 offset:55296
s_waitcnt lgkmcnt(0)
v_mfma_f32_16x16x32_bf16 v[212:215], v[24:27], v[64:67], v[212:215]
v_mfma_f32_16x16x32_bf16 v[212:215], v[28:31], v[68:71], v[212:215]
v_mfma_f32_16x16x32_bf16 v[220:223], v[24:27], v[72:75], v[220:223]
v_mfma_f32_16x16x32_bf16 v[220:223], v[28:31], v[76:79], v[220:223]
ds_read_b128 v[32:35], v0 offset:57344
s_waitcnt lgkmcnt(0)
ds_read_b128 v[36:39], v1 offset:57344
s_waitcnt lgkmcnt(0)
v_mfma_f32_16x16x32_bf16 v[224:227], v[32:35], v[64:67], v[224:227]
v_mfma_f32_16x16x32_bf16 v[224:227], v[36:39], v[68:71], v[224:227]
v_mfma_f32_16x16x32_bf16 v[232:235], v[32:35], v[72:75], v[232:235]
v_mfma_f32_16x16x32_bf16 v[232:235], v[36:39], v[76:79], v[232:235]
ds_read_b128 v[40:43], v0 offset:59392
s_waitcnt vmcnt(2)
s_add_u32 m0, s32, 98304
s_xor_b32 s35, s34, 131456
buffer_load_dwordx4 v12, s[16:19], s35 offen nt lds
s_waitcnt lgkmcnt(0)
ds_read_b128 v[44:47], v1 offset:59392
s_waitcnt lgkmcnt(0)
v_mfma_f32_16x16x32_bf16 v[228:231], v[40:43], v[64:67], v[228:231]
v_mfma_f32_16x16x32_bf16 v[228:231], v[44:47], v[68:71], v[228:231]
v_mfma_f32_16x16x32_bf16 v[236:239], v[40:43], v[72:75], v[236:239]
v_mfma_f32_16x16x32_bf16 v[236:239], v[44:47], v[76:79], v[236:239]
ds_read_b128 v[24:27], v0 offset:61440
s_waitcnt lgkmcnt(0)
ds_read_b128 v[28:31], v1 offset:61440
s_waitcnt lgkmcnt(0)
v_mfma_f32_16x16x32_bf16 v[240:243], v[24:27], v[64:67], v[240:243]
v_mfma_f32_16x16x32_bf16 v[240:243], v[28:31], v[68:71], v[240:243]
v_mfma_f32_16x16x32_bf16 v[248:251], v[24:27], v[72:75], v[248:251]
v_mfma_f32_16x16x32_bf16 v[248:251], v[28:31], v[76:79], v[248:251]
ds_read_b128 v[32:35], v0 offset:63488
ds_read_b128 v[56:59], v8 offset:16384
ds_read_b128 v[60:63], v9 offset:16384
s_waitcnt lgkmcnt(0)
s_waitcnt vmcnt(2)
s_add_u32 m0, s32, 147456
s_xor_b32 s35, s33, 139648
buffer_load_dwordx4 v10, s[12:15], s35 offen nt lds
ds_read_b128 v[36:39], v1 offset:63488
s_waitcnt lgkmcnt(0)
v_mfma_f32_16x16x32_bf16 v[244:247], v[32:35], v[64:67], v[244:247]
v_mfma_f32_16x16x32_bf16 v[244:247], v[36:39], v[68:71], v[244:247]
v_mfma_f32_16x16x32_bf16 v[252:255], v[32:35], v[72:75], v[252:255]
v_mfma_f32_16x16x32_bf16 v[252:255], v[36:39], v[76:79], v[252:255]
s_barrier
ds_read_b128 v[40:43], v2 offset:0
s_waitcnt lgkmcnt(0)
ds_read_b128 v[44:47], v3 offset:0
s_waitcnt lgkmcnt(0)
v_mfma_f32_16x16x32_bf16 v[128:131], v[40:43], v[48:51], v[128:131]
v_mfma_f32_16x16x32_bf16 v[128:131], v[44:47], v[52:55], v[128:131]
v_mfma_f32_16x16x32_bf16 v[136:139], v[40:43], v[56:59], v[136:139]
v_mfma_f32_16x16x32_bf16 v[136:139], v[44:47], v[60:63], v[136:139]
ds_read_b128 v[24:27], v2 offset:2048
s_waitcnt lgkmcnt(0)
ds_read_b128 v[28:31], v3 offset:2048
s_waitcnt lgkmcnt(0)
v_mfma_f32_16x16x32_bf16 v[132:135], v[24:27], v[48:51], v[132:135]
v_mfma_f32_16x16x32_bf16 v[132:135], v[28:31], v[52:55], v[132:135]
v_mfma_f32_16x16x32_bf16 v[140:143], v[24:27], v[56:59], v[140:143]
v_mfma_f32_16x16x32_bf16 v[140:143], v[28:31], v[60:63], v[140:143]
ds_read_b128 v[32:35], v2 offset:4096
s_waitcnt vmcnt(2)
s_add_u32 m0, s32, 106496
s_xor_b32 s35, s34, 164224
buffer_load_dwordx4 v12, s[16:19], s35 offen nt lds
s_waitcnt lgkmcnt(0)
ds_read_b128 v[36:39], v3 offset:4096
s_waitcnt lgkmcnt(0)
v_mfma_f32_16x16x32_bf16 v[144:147], v[32:35], v[48:51], v[144:147]
v_mfma_f32_16x16x32_bf16 v[144:147], v[36:39], v[52:55], v[144:147]
v_mfma_f32_16x16x32_bf16 v[152:155], v[32:35], v[56:59], v[152:155]
v_mfma_f32_16x16x32_bf16 v[152:155], v[36:39], v[60:63], v[152:155]
ds_read_b128 v[40:43], v2 offset:6144
s_waitcnt lgkmcnt(0)
ds_read_b128 v[44:47], v3 offset:6144
s_waitcnt lgkmcnt(0)
v_mfma_f32_16x16x32_bf16 v[148:151], v[40:43], v[48:51], v[148:151]
v_mfma_f32_16x16x32_bf16 v[148:151], v[44:47], v[52:55], v[148:151]
v_mfma_f32_16x16x32_bf16 v[156:159], v[40:43], v[56:59], v[156:159]
v_mfma_f32_16x16x32_bf16 v[156:159], v[44:47], v[60:63], v[156:159]
ds_read_b128 v[24:27], v2 offset:8192
s_waitcnt vmcnt(2)
s_add_u32 m0, s32, 155648
s_xor_b32 s35, s33, 139648
buffer_load_dwordx4 v11, s[12:15], s35 offen nt lds
s_waitcnt lgkmcnt(0)
ds_read_b128 v[28:31], v3 offset:8192
s_waitcnt lgkmcnt(0)
v_mfma_f32_16x16x32_bf16 v[160:163], v[24:27], v[48:51], v[160:163]
v_mfma_f32_16x16x32_bf16 v[160:163], v[28:31], v[52:55], v[160:163]
v_mfma_f32_16x16x32_bf16 v[168:171], v[24:27], v[56:59], v[168:171]
v_mfma_f32_16x16x32_bf16 v[168:171], v[28:31], v[60:63], v[168:171]
ds_read_b128 v[32:35], v2 offset:10240
s_waitcnt lgkmcnt(0)
ds_read_b128 v[36:39], v3 offset:10240
s_waitcnt lgkmcnt(0)
v_mfma_f32_16x16x32_bf16 v[164:167], v[32:35], v[48:51], v[164:167]
v_mfma_f32_16x16x32_bf16 v[164:167], v[36:39], v[52:55], v[164:167]
v_mfma_f32_16x16x32_bf16 v[172:175], v[32:35], v[56:59], v[172:175]
v_mfma_f32_16x16x32_bf16 v[172:175], v[36:39], v[60:63], v[172:175]
ds_read_b128 v[40:43], v2 offset:12288
s_waitcnt vmcnt(2)
s_add_u32 m0, s32, 114688
s_xor_b32 s35, s34, 196992
buffer_load_dwordx4 v12, s[16:19], s35 offen nt lds
s_waitcnt lgkmcnt(0)
ds_read_b128 v[44:47], v3 offset:12288
s_waitcnt lgkmcnt(0)
v_mfma_f32_16x16x32_bf16 v[176:179], v[40:43], v[48:51], v[176:179]
v_mfma_f32_16x16x32_bf16 v[176:179], v[44:47], v[52:55], v[176:179]
v_mfma_f32_16x16x32_bf16 v[184:187], v[40:43], v[56:59], v[184:187]
v_mfma_f32_16x16x32_bf16 v[184:187], v[44:47], v[60:63], v[184:187]
ds_read_b128 v[24:27], v2 offset:14336
s_waitcnt lgkmcnt(0)
ds_read_b128 v[28:31], v3 offset:14336
s_waitcnt lgkmcnt(0)
v_mfma_f32_16x16x32_bf16 v[180:183], v[24:27], v[48:51], v[180:183]
v_mfma_f32_16x16x32_bf16 v[180:183], v[28:31], v[52:55], v[180:183]
v_mfma_f32_16x16x32_bf16 v[188:191], v[24:27], v[56:59], v[188:191]
v_mfma_f32_16x16x32_bf16 v[188:191], v[28:31], v[60:63], v[188:191]
s_barrier
ds_read_b128 v[32:35], v2 offset:16384
s_waitcnt lgkmcnt(0)
ds_read_b128 v[36:39], v3 offset:16384
s_waitcnt lgkmcnt(0)
v_mfma_f32_16x16x32_bf16 v[192:195], v[32:35], v[48:51], v[192:195]
v_mfma_f32_16x16x32_bf16 v[192:195], v[36:39], v[52:55], v[192:195]
v_mfma_f32_16x16x32_bf16 v[200:203], v[32:35], v[56:59], v[200:203]
v_mfma_f32_16x16x32_bf16 v[200:203], v[36:39], v[60:63], v[200:203]
ds_read_b128 v[40:43], v2 offset:18432
s_waitcnt vmcnt(2)
s_add_u32 m0, s32, 122880
s_xor_b32 s35, s34, 229760
buffer_load_dwordx4 v12, s[16:19], s35 offen nt lds
s_waitcnt lgkmcnt(0)
ds_read_b128 v[44:47], v3 offset:18432
s_waitcnt lgkmcnt(0)
v_mfma_f32_16x16x32_bf16 v[196:199], v[40:43], v[48:51], v[196:199]
v_mfma_f32_16x16x32_bf16 v[196:199], v[44:47], v[52:55], v[196:199]
v_mfma_f32_16x16x32_bf16 v[204:207], v[40:43], v[56:59], v[204:207]
v_mfma_f32_16x16x32_bf16 v[204:207], v[44:47], v[60:63], v[204:207]
ds_read_b128 v[24:27], v2 offset:20480
s_waitcnt lgkmcnt(0)
ds_read_b128 v[28:31], v3 offset:20480
s_waitcnt lgkmcnt(0)
v_mfma_f32_16x16x32_bf16 v[208:211], v[24:27], v[48:51], v[208:211]
v_mfma_f32_16x16x32_bf16 v[208:211], v[28:31], v[52:55], v[208:211]
v_mfma_f32_16x16x32_bf16 v[216:219], v[24:27], v[56:59], v[216:219]
v_mfma_f32_16x16x32_bf16 v[216:219], v[28:31], v[60:63], v[216:219]
ds_read_b128 v[32:35], v2 offset:22528
s_waitcnt vmcnt(2)
s_add_u32 m0, s32, 0
s_xor_b32 s35, s36, 131072
buffer_load_dwordx4 v13, s[20:23], s35 offen nt lds
s_waitcnt lgkmcnt(0)
ds_read_b128 v[36:39], v3 offset:22528
s_waitcnt lgkmcnt(0)
v_mfma_f32_16x16x32_bf16 v[212:215], v[32:35], v[48:51], v[212:215]
v_mfma_f32_16x16x32_bf16 v[212:215], v[36:39], v[52:55], v[212:215]
v_mfma_f32_16x16x32_bf16 v[220:223], v[32:35], v[56:59], v[220:223]
v_mfma_f32_16x16x32_bf16 v[220:223], v[36:39], v[60:63], v[220:223]
ds_read_b128 v[40:43], v2 offset:24576
s_waitcnt lgkmcnt(0)
ds_read_b128 v[44:47], v3 offset:24576
s_waitcnt lgkmcnt(0)
v_mfma_f32_16x16x32_bf16 v[224:227], v[40:43], v[48:51], v[224:227]
v_mfma_f32_16x16x32_bf16 v[224:227], v[44:47], v[52:55], v[224:227]
v_mfma_f32_16x16x32_bf16 v[232:235], v[40:43], v[56:59], v[232:235]
v_mfma_f32_16x16x32_bf16 v[232:235], v[44:47], v[60:63], v[232:235]
ds_read_b128 v[24:27], v2 offset:26624
s_waitcnt vmcnt(2)
s_add_u32 m0, s32, 8192
s_xor_b32 s35, s36, 163840
buffer_load_dwordx4 v13, s[20:23], s35 offen nt lds
s_waitcnt lgkmcnt(0)
ds_read_b128 v[28:31], v3 offset:26624
s_waitcnt lgkmcnt(0)
v_mfma_f32_16x16x32_bf16 v[228:231], v[24:27], v[48:51], v[228:231]
v_mfma_f32_16x16x32_bf16 v[228:231], v[28:31], v[52:55], v[228:231]
v_mfma_f32_16x16x32_bf16 v[236:239], v[24:27], v[56:59], v[236:239]
v_mfma_f32_16x16x32_bf16 v[236:239], v[28:31], v[60:63], v[236:239]
ds_read_b128 v[32:35], v2 offset:28672
s_waitcnt lgkmcnt(0)
ds_read_b128 v[36:39], v3 offset:28672
s_waitcnt lgkmcnt(0)
v_mfma_f32_16x16x32_bf16 v[240:243], v[32:35], v[48:51], v[240:243]
v_mfma_f32_16x16x32_bf16 v[240:243], v[36:39], v[52:55], v[240:243]
v_mfma_f32_16x16x32_bf16 v[248:251], v[32:35], v[56:59], v[248:251]
v_mfma_f32_16x16x32_bf16 v[248:251], v[36:39], v[60:63], v[248:251]
ds_read_b128 v[40:43], v2 offset:30720
s_waitcnt lgkmcnt(0)
ds_read_b128 v[44:47], v3 offset:30720
s_waitcnt lgkmcnt(0)
v_mfma_f32_16x16x32_bf16 v[244:247], v[40:43], v[48:51], v[244:247]
v_mfma_f32_16x16x32_bf16 v[244:247], v[44:47], v[52:55], v[244:247]
v_mfma_f32_16x16x32_bf16 v[252:255], v[40:43], v[56:59], v[252:255]
v_mfma_f32_16x16x32_bf16 v[252:255], v[44:47], v[60:63], v[252:255]
ds_read_b128 v[64:67], v8 offset:0
ds_read_b128 v[68:71], v9 offset:0
ds_read_b128 v[72:75], v8 offset:16384
ds_read_b128 v[76:79], v9 offset:16384
s_waitcnt vmcnt(2)
s_add_u32 m0, s32, 16384
s_xor_b32 s35, s36, 196608
buffer_load_dwordx4 v13, s[20:23], s35 offen nt lds
s_barrier
ds_read_b128 v[24:27], v2 offset:32768
s_waitcnt lgkmcnt(0)
ds_read_b128 v[28:31], v3 offset:32768
s_waitcnt lgkmcnt(0)
v_mfma_f32_16x16x32_bf16 v[128:131], v[24:27], v[64:67], v[128:131]
v_mfma_f32_16x16x32_bf16 v[128:131], v[28:31], v[68:71], v[128:131]
v_mfma_f32_16x16x32_bf16 v[136:139], v[24:27], v[72:75], v[136:139]
v_mfma_f32_16x16x32_bf16 v[136:139], v[28:31], v[76:79], v[136:139]
ds_read_b128 v[32:35], v2 offset:34816
s_waitcnt lgkmcnt(0)
ds_read_b128 v[36:39], v3 offset:34816
s_waitcnt lgkmcnt(0)
v_mfma_f32_16x16x32_bf16 v[132:135], v[32:35], v[64:67], v[132:135]
v_mfma_f32_16x16x32_bf16 v[132:135], v[36:39], v[68:71], v[132:135]
v_mfma_f32_16x16x32_bf16 v[140:143], v[32:35], v[72:75], v[140:143]
v_mfma_f32_16x16x32_bf16 v[140:143], v[36:39], v[76:79], v[140:143]
ds_read_b128 v[40:43], v2 offset:36864
s_waitcnt vmcnt(2)
s_add_u32 m0, s32, 24576
s_xor_b32 s35, s36, 229376
buffer_load_dwordx4 v13, s[20:23], s35 offen nt lds
s_waitcnt lgkmcnt(0)
ds_read_b128 v[44:47], v3 offset:36864
s_waitcnt lgkmcnt(0)
v_mfma_f32_16x16x32_bf16 v[144:147], v[40:43], v[64:67], v[144:147]
v_mfma_f32_16x16x32_bf16 v[144:147], v[44:47], v[68:71], v[144:147]
v_mfma_f32_16x16x32_bf16 v[152:155], v[40:43], v[72:75], v[152:155]
v_mfma_f32_16x16x32_bf16 v[152:155], v[44:47], v[76:79], v[152:155]
ds_read_b128 v[24:27], v2 offset:38912
v_max_f32 v16, v128, v129
v_max_f32 v17, v136, v137
s_waitcnt lgkmcnt(0)
ds_read_b128 v[28:31], v3 offset:38912
s_waitcnt lgkmcnt(0)
v_mfma_f32_16x16x32_bf16 v[148:151], v[24:27], v[64:67], v[148:151]
v_mfma_f32_16x16x32_bf16 v[148:151], v[28:31], v[68:71], v[148:151]
v_max3_f32 v16, v16, v130, v131
v_max3_f32 v17, v17, v138, v139
v_mfma_f32_16x16x32_bf16 v[156:159], v[24:27], v[72:75], v[156:159]
v_mfma_f32_16x16x32_bf16 v[156:159], v[28:31], v[76:79], v[156:159]
ds_read_b128 v[32:35], v2 offset:40960
v_max3_f32 v16, v16, v132, v133
v_max3_f32 v17, v17, v140, v141
s_waitcnt vmcnt(2)
s_add_u32 m0, s32, 32768
s_xor_b32 s35, s36, 131200
buffer_load_dwordx4 v13, s[20:23], s35 offen nt lds
s_waitcnt lgkmcnt(0)
ds_read_b128 v[36:39], v3 offset:40960
s_waitcnt lgkmcnt(0)
v_mfma_f32_16x16x32_bf16 v[160:163], v[32:35], v[64:67], v[160:163]
v_mfma_f32_16x16x32_bf16 v[160:163], v[36:39], v[68:71], v[160:163]
v_max3_f32 v16, v16, v134, v135
v_max3_f32 v17, v17, v142, v143
v_mfma_f32_16x16x32_bf16 v[168:171], v[32:35], v[72:75], v[168:171]
v_mfma_f32_16x16x32_bf16 v[168:171], v[36:39], v[76:79], v[168:171]
ds_read_b128 v[40:43], v2 offset:43008
v_max3_f32 v16, v16, v144, v145
v_max3_f32 v17, v17, v152, v153
s_waitcnt lgkmcnt(0)
ds_read_b128 v[44:47], v3 offset:43008
s_waitcnt lgkmcnt(0)
v_mfma_f32_16x16x32_bf16 v[164:167], v[40:43], v[64:67], v[164:167]
v_mfma_f32_16x16x32_bf16 v[164:167], v[44:47], v[68:71], v[164:167]
v_max3_f32 v16, v16, v146, v147
v_max3_f32 v17, v17, v154, v155
v_mfma_f32_16x16x32_bf16 v[172:175], v[40:43], v[72:75], v[172:175]
v_mfma_f32_16x16x32_bf16 v[172:175], v[44:47], v[76:79], v[172:175]
ds_read_b128 v[24:27], v2 offset:45056
v_max3_f32 v16, v16, v148, v149
v_max3_f32 v17, v17, v156, v157
s_waitcnt vmcnt(2)
s_add_u32 m0, s32, 40960
s_xor_b32 s35, s36, 163968
buffer_load_dwordx4 v13, s[20:23], s35 offen nt lds
s_waitcnt lgkmcnt(0)
ds_read_b128 v[28:31], v3 offset:45056
s_waitcnt lgkmcnt(0)
v_mfma_f32_16x16x32_bf16 v[176:179], v[24:27], v[64:67], v[176:179]
v_mfma_f32_16x16x32_bf16 v[176:179], v[28:31], v[68:71], v[176:179]
v_max3_f32 v16, v16, v150, v151
v_max3_f32 v17, v17, v158, v159
v_mfma_f32_16x16x32_bf16 v[184:187], v[24:27], v[72:75], v[184:187]
v_mfma_f32_16x16x32_bf16 v[184:187], v[28:31], v[76:79], v[184:187]
ds_read_b128 v[32:35], v2 offset:47104
v_max3_f32 v16, v16, v160, v161
v_max3_f32 v17, v17, v168, v169
s_waitcnt lgkmcnt(0)
ds_read_b128 v[36:39], v3 offset:47104
s_waitcnt lgkmcnt(0)
v_mfma_f32_16x16x32_bf16 v[180:183], v[32:35], v[64:67], v[180:183]
v_mfma_f32_16x16x32_bf16 v[180:183], v[36:39], v[68:71], v[180:183]
v_max3_f32 v16, v16, v162, v163
v_max3_f32 v17, v17, v170, v171
v_mfma_f32_16x16x32_bf16 v[188:191], v[32:35], v[72:75], v[188:191]
v_mfma_f32_16x16x32_bf16 v[188:191], v[36:39], v[76:79], v[188:191]
v_max3_f32 v16, v16, v164, v165
v_max3_f32 v17, v17, v172, v173
s_barrier
ds_read_b128 v[40:43], v2 offset:49152
s_waitcnt lgkmcnt(0)
ds_read_b128 v[44:47], v3 offset:49152
s_waitcnt lgkmcnt(0)
v_mfma_f32_16x16x32_bf16 v[192:195], v[40:43], v[64:67], v[192:195]
v_mfma_f32_16x16x32_bf16 v[192:195], v[44:47], v[68:71], v[192:195]
v_max3_f32 v16, v16, v166, v167
v_max3_f32 v17, v17, v174, v175
v_mfma_f32_16x16x32_bf16 v[200:203], v[40:43], v[72:75], v[200:203]
v_mfma_f32_16x16x32_bf16 v[200:203], v[44:47], v[76:79], v[200:203]
ds_read_b128 v[24:27], v2 offset:51200
v_max3_f32 v16, v16, v176, v177
v_max3_f32 v17, v17, v184, v185
s_waitcnt vmcnt(2)
s_add_u32 m0, s32, 49152
s_xor_b32 s35, s36, 196736
buffer_load_dwordx4 v13, s[20:23], s35 offen nt lds
s_waitcnt lgkmcnt(0)
ds_read_b128 v[28:31], v3 offset:51200
s_waitcnt lgkmcnt(0)
v_mfma_f32_16x16x32_bf16 v[196:199], v[24:27], v[64:67], v[196:199]
v_mfma_f32_16x16x32_bf16 v[196:199], v[28:31], v[68:71], v[196:199]
v_max3_f32 v16, v16, v178, v179
v_max3_f32 v17, v17, v186, v187
v_mfma_f32_16x16x32_bf16 v[204:207], v[24:27], v[72:75], v[204:207]
v_mfma_f32_16x16x32_bf16 v[204:207], v[28:31], v[76:79], v[204:207]
ds_read_b128 v[32:35], v2 offset:53248
v_max3_f32 v16, v16, v180, v181
v_max3_f32 v17, v17, v188, v189
s_waitcnt lgkmcnt(0)
ds_read_b128 v[36:39], v3 offset:53248
s_waitcnt lgkmcnt(0)
v_mfma_f32_16x16x32_bf16 v[208:211], v[32:35], v[64:67], v[208:211]
v_mfma_f32_16x16x32_bf16 v[208:211], v[36:39], v[68:71], v[208:211]
v_max3_f32 v16, v16, v182, v183
v_max3_f32 v17, v17, v190, v191
v_mfma_f32_16x16x32_bf16 v[216:219], v[32:35], v[72:75], v[216:219]
v_mfma_f32_16x16x32_bf16 v[216:219], v[36:39], v[76:79], v[216:219]
ds_read_b128 v[40:43], v2 offset:55296
v_max3_f32 v16, v16, v192, v193
v_max3_f32 v17, v17, v200, v201
s_waitcnt vmcnt(2)
s_add_u32 m0, s32, 57344
s_xor_b32 s35, s36, 229504
buffer_load_dwordx4 v13, s[20:23], s35 offen nt lds
s_waitcnt lgkmcnt(0)
ds_read_b128 v[44:47], v3 offset:55296
s_waitcnt lgkmcnt(0)
v_mfma_f32_16x16x32_bf16 v[212:215], v[40:43], v[64:67], v[212:215]
v_mfma_f32_16x16x32_bf16 v[212:215], v[44:47], v[68:71], v[212:215]
v_max3_f32 v16, v16, v194, v195
v_max3_f32 v17, v17, v202, v203
v_mfma_f32_16x16x32_bf16 v[220:223], v[40:43], v[72:75], v[220:223]
v_mfma_f32_16x16x32_bf16 v[220:223], v[44:47], v[76:79], v[220:223]
ds_read_b128 v[24:27], v2 offset:57344
v_max3_f32 v16, v16, v196, v197
v_max3_f32 v17, v17, v204, v205
s_waitcnt lgkmcnt(0)
ds_read_b128 v[28:31], v3 offset:57344
s_waitcnt lgkmcnt(0)
v_mfma_f32_16x16x32_bf16 v[224:227], v[24:27], v[64:67], v[224:227]
v_mfma_f32_16x16x32_bf16 v[224:227], v[28:31], v[68:71], v[224:227]
v_max3_f32 v16, v16, v198, v199
v_max3_f32 v17, v17, v206, v207
v_mfma_f32_16x16x32_bf16 v[232:235], v[24:27], v[72:75], v[232:235]
v_mfma_f32_16x16x32_bf16 v[232:235], v[28:31], v[76:79], v[232:235]
ds_read_b128 v[32:35], v2 offset:59392
v_max3_f32 v16, v16, v208, v209
v_max3_f32 v17, v17, v216, v217
s_waitcnt vmcnt(2)
s_add_u32 m0, s32, 65536
s_xor_b32 s35, s36, 131328
buffer_load_dwordx4 v13, s[20:23], s35 offen nt lds
s_waitcnt lgkmcnt(0)
ds_read_b128 v[36:39], v3 offset:59392
s_waitcnt lgkmcnt(0)
v_mfma_f32_16x16x32_bf16 v[228:231], v[32:35], v[64:67], v[228:231]
v_mfma_f32_16x16x32_bf16 v[228:231], v[36:39], v[68:71], v[228:231]
v_max3_f32 v16, v16, v210, v211
v_max3_f32 v17, v17, v218, v219
v_mfma_f32_16x16x32_bf16 v[236:239], v[32:35], v[72:75], v[236:239]
v_mfma_f32_16x16x32_bf16 v[236:239], v[36:39], v[76:79], v[236:239]
ds_read_b128 v[40:43], v2 offset:61440
v_max3_f32 v16, v16, v212, v213
v_max3_f32 v17, v17, v220, v221
s_waitcnt lgkmcnt(0)
ds_read_b128 v[44:47], v3 offset:61440
s_waitcnt lgkmcnt(0)
v_mfma_f32_16x16x32_bf16 v[240:243], v[40:43], v[64:67], v[240:243]
v_mfma_f32_16x16x32_bf16 v[240:243], v[44:47], v[68:71], v[240:243]
v_max3_f32 v16, v16, v214, v215
v_max3_f32 v17, v17, v222, v223
v_mfma_f32_16x16x32_bf16 v[248:251], v[40:43], v[72:75], v[248:251]
v_mfma_f32_16x16x32_bf16 v[248:251], v[44:47], v[76:79], v[248:251]
ds_read_b128 v[24:27], v2 offset:63488
v_max3_f32 v16, v16, v224, v225
v_max3_f32 v17, v17, v232, v233
s_waitcnt vmcnt(2)
s_add_u32 m0, s32, 73728
s_xor_b32 s35, s36, 164096
buffer_load_dwordx4 v13, s[20:23], s35 offen nt lds
s_waitcnt lgkmcnt(0)
ds_read_b128 v[28:31], v3 offset:63488
s_waitcnt lgkmcnt(0)
v_mfma_f32_16x16x32_bf16 v[244:247], v[24:27], v[64:67], v[244:247]
v_mfma_f32_16x16x32_bf16 v[244:247], v[28:31], v[68:71], v[244:247]
v_max3_f32 v16, v16, v226, v227
v_max3_f32 v17, v17, v234, v235
v_mfma_f32_16x16x32_bf16 v[252:255], v[24:27], v[72:75], v[252:255]
v_mfma_f32_16x16x32_bf16 v[252:255], v[28:31], v[76:79], v[252:255]
v_max3_f32 v16, v16, v228, v229
v_max3_f32 v17, v17, v236, v237
v_max3_f32 v16, v16, v230, v231
v_max3_f32 v17, v17, v238, v239
.p2align 3
L_qb_join:
s_barrier
ds_read_b64_tr_b16 v[24:25], v4 offset:0
ds_read_b64_tr_b16 v[26:27], v4 offset:2048
ds_read_b64_tr_b16 v[28:29], v4 offset:4096
ds_read_b64_tr_b16 v[30:31], v4 offset:6144
ds_read_b64_tr_b16 v[32:33], v5 offset:0
ds_read_b64_tr_b16 v[34:35], v5 offset:2048
ds_read_b64_tr_b16 v[36:37], v5 offset:4096
ds_read_b64_tr_b16 v[38:39], v5 offset:6144
v_max3_f32 v16, v16, v240, v241
v_max3_f32 v17, v17, v248, v249
v_max3_f32 v16, v16, v242, v243
v_max3_f32 v17, v17, v250, v251
v_max3_f32 v16, v16, v244, v245
v_max3_f32 v17, v17, v252, v253
v_max3_f32 v16, v16, v246, v247
v_max3_f32 v17, v17, v254, v255
s_nop 1
v_permlane32_swap_b32 v16, v17
v_mov_b32 v80, 0x3f803f80
v_max_f32 v16, v16, v17
v_mov_b32 v17, v16
v_mov_b32 v81, 0x3f803f80
v_mov_b32 v82, 0x3f803f80
v_permlane16_swap_b32 v16, v17
v_mov_b32 v83, 0x3f803f80
v_max_f32 v16, v16, v17
v_mul_f32 v16, s37, v16
v_mov_b32 v17, v16
s_nop 1
v_permlane32_swap_b32 v16, v17
s_nop 0
v_fma_f32 v128, v128, s37, -v16
v_fma_f32 v129, v129, s37, -v16
v_exp_f32 v128, v128
v_fma_f32 v130, v130, s37, -v16
v_exp_f32 v129, v129
v_fma_f32 v131, v131, s37, -v16
v_exp_f32 v130, v130
v_cvt_pk_bf16_f32 v128, v128, v129
v_fma_f32 v132, v132, s37, -v16
v_exp_f32 v131, v131
v_fma_f32 v133, v133, s37, -v16
v_exp_f32 v132, v132
v_cvt_pk_bf16_f32 v129, v130, v131
v_fma_f32 v134, v134, s37, -v16
v_exp_f32 v133, v133
v_fma_f32 v135, v135, s37, -v16
v_exp_f32 v134, v134
v_cvt_pk_bf16_f32 v130, v132, v133
v_fma_f32 v136, v136, s37, -v17
v_exp_f32 v135, v135
v_fma_f32 v137, v137, s37, -v17
v_exp_f32 v136, v136
v_cvt_pk_bf16_f32 v131, v134, v135
s_add_u32 m0, s32, 81920
s_xor_b32 s35, s36, 196864
buffer_load_dwordx4 v13, s[20:23], s35 offen nt lds
v_fma_f32 v138, v138, s37, -v17
v_exp_f32 v137, v137
v_fma_f32 v139, v139, s37, -v17
v_exp_f32 v138, v138
v_cvt_pk_bf16_f32 v132, v136, v137
v_fma_f32 v140, v140, s37, -v17
v_exp_f32 v139, v139
v_fma_f32 v141, v141, s37, -v17
v_exp_f32 v140, v140
v_cvt_pk_bf16_f32 v133, v138, v139
v_fma_f32 v142, v142, s37, -v17
v_exp_f32 v141, v141
v_fma_f32 v143, v143, s37, -v17
v_exp_f32 v142, v142
v_cvt_pk_bf16_f32 v134, v140, v141
v_fma_f32 v144, v144, s37, -v16
v_exp_f32 v143, v143
v_fma_f32 v145, v145, s37, -v16
v_exp_f32 v144, v144
v_cvt_pk_bf16_f32 v135, v142, v143
v_fma_f32 v146, v146, s37, -v16
v_exp_f32 v145, v145
v_fma_f32 v147, v147, s37, -v16
v_exp_f32 v146, v146
v_cvt_pk_bf16_f32 v136, v144, v145
v_fma_f32 v148, v148, s37, -v16
v_exp_f32 v147, v147
v_fma_f32 v149, v149, s37, -v16
v_exp_f32 v148, v148
v_cvt_pk_bf16_f32 v137, v146, v147
v_fma_f32 v150, v150, s37, -v16
v_exp_f32 v149, v149
v_fma_f32 v151, v151, s37, -v16
v_exp_f32 v150, v150
v_cvt_pk_bf16_f32 v138, v148, v149
v_fma_f32 v152, v152, s37, -v17
v_exp_f32 v151, v151
v_fma_f32 v153, v153, s37, -v17
v_exp_f32 v152, v152
v_cvt_pk_bf16_f32 v139, v150, v151
s_add_u32 m0, s32, 90112
s_xor_b32 s35, s36, 229632
buffer_load_dwordx4 v13, s[20:23], s35 offen nt lds
v_fma_f32 v154, v154, s37, -v17
v_exp_f32 v153, v153
v_fma_f32 v155, v155, s37, -v17
v_exp_f32 v154, v154
v_cvt_pk_bf16_f32 v140, v152, v153
v_fma_f32 v156, v156, s37, -v17
v_exp_f32 v155, v155
v_fma_f32 v157, v157, s37, -v17
v_exp_f32 v156, v156
v_cvt_pk_bf16_f32 v141, v154, v155
v_fma_f32 v158, v158, s37, -v17
v_exp_f32 v157, v157
v_fma_f32 v159, v159, s37, -v17
v_exp_f32 v158, v158
v_cvt_pk_bf16_f32 v142, v156, v157
v_fma_f32 v160, v160, s37, -v16
v_exp_f32 v159, v159
v_fma_f32 v161, v161, s37, -v16
v_exp_f32 v160, v160
v_cvt_pk_bf16_f32 v143, v158, v159
v_fma_f32 v162, v162, s37, -v16
v_exp_f32 v161, v161
s_waitcnt lgkmcnt(4)
v_mfma_f32_16x16x32_bf16 v[48:51], v[24:27], v[128:131], 0
ds_read_b64_tr_b16 v[40:41], v6 offset:0
v_mfma_f32_16x16x32_bf16 v[48:51], v[28:31], v[136:139], v[48:51]
ds_read_b64_tr_b16 v[42:43], v6 offset:2048
v_fma_f32 v163, v163, s37, -v16
v_exp_f32 v162, v162
v_cvt_pk_bf16_f32 v144, v160, v161
v_fma_f32 v164, v164, s37, -v16
v_exp_f32 v163, v163
v_fma_f32 v165, v165, s37, -v16
v_exp_f32 v164, v164
v_cvt_pk_bf16_f32 v145, v162, v163
v_fma_f32 v166, v166, s37, -v16
v_exp_f32 v165, v165
s_waitcnt lgkmcnt(4)
v_mfma_f32_16x16x32_bf16 v[64:67], v[24:27], v[132:135], 0
ds_read_b64_tr_b16 v[44:45], v6 offset:4096
v_mfma_f32_16x16x32_bf16 v[64:67], v[28:31], v[140:143], v[64:67]
ds_read_b64_tr_b16 v[46:47], v6 offset:6144
v_fma_f32 v167, v167, s37, -v16
v_exp_f32 v166, v166
v_cvt_pk_bf16_f32 v146, v164, v165
v_fma_f32 v168, v168, s37, -v17
v_exp_f32 v167, v167
v_fma_f32 v169, v169, s37, -v17
v_exp_f32 v168, v168
v_cvt_pk_bf16_f32 v147, v166, v167
v_fma_f32 v170, v170, s37, -v17
v_exp_f32 v169, v169
s_add_u32 m0, s32, 98304
s_xor_b32 s35, s36, 131456
buffer_load_dwordx4 v13, s[20:23], s35 offen nt lds
s_waitcnt lgkmcnt(4)
v_mfma_f32_16x16x32_bf16 v[56:59], v[32:35], v[128:131], 0
ds_read_b64_tr_b16 v[24:25], v7 offset:0
v_mfma_f32_16x16x32_bf16 v[56:59], v[36:39], v[136:139], v[56:59]
ds_read_b64_tr_b16 v[26:27], v7 offset:2048
v_fma_f32 v171, v171, s37, -v17
v_exp_f32 v170, v170
v_cvt_pk_bf16_f32 v148, v168, v169
v_fma_f32 v172, v172, s37, -v17
v_exp_f32 v171, v171
v_mfma_f32_16x16x32_bf16 v[84:87], v[80:83], v[128:131], 0
v_mfma_f32_16x16x32_bf16 v[84:87], v[80:83], v[136:139], v[84:87]
v_fma_f32 v173, v173, s37, -v17
v_exp_f32 v172, v172
v_cvt_pk_bf16_f32 v149, v170, v171
v_fma_f32 v174, v174, s37, -v17
v_exp_f32 v173, v173
s_waitcnt lgkmcnt(4)
v_mfma_f32_16x16x32_bf16 v[72:75], v[32:35], v[132:135], 0
ds_read_b64_tr_b16 v[28:29], v7 offset:4096
v_mfma_f32_16x16x32_bf16 v[72:75], v[36:39], v[140:143], v[72:75]
ds_read_b64_tr_b16 v[30:31], v7 offset:6144
v_fma_f32 v175, v175, s37, -v17
v_exp_f32 v174, v174
v_cvt_pk_bf16_f32 v150, v172, v173
v_fma_f32 v176, v176, s37, -v16
v_exp_f32 v175, v175
v_fma_f32 v177, v177, s37, -v16
v_exp_f32 v176, v176
v_cvt_pk_bf16_f32 v151, v174, v175
v_fma_f32 v178, v178, s37, -v16
v_exp_f32 v177, v177
s_waitcnt lgkmcnt(4)
v_mfma_f32_16x16x32_bf16 v[52:55], v[40:43], v[128:131], 0
ds_read_b64_tr_b16 v[32:33], v4 offset:8192
v_mfma_f32_16x16x32_bf16 v[52:55], v[44:47], v[136:139], v[52:55]
ds_read_b64_tr_b16 v[34:35], v4 offset:10240
v_fma_f32 v179, v179, s37, -v16
v_exp_f32 v178, v178
v_cvt_pk_bf16_f32 v152, v176, v177
v_fma_f32 v180, v180, s37, -v16
v_exp_f32 v179, v179
v_fma_f32 v181, v181, s37, -v16
v_exp_f32 v180, v180
v_cvt_pk_bf16_f32 v153, v178, v179
v_fma_f32 v182, v182, s37, -v16
v_exp_f32 v181, v181
s_add_u32 m0, s32, 106496
s_xor_b32 s35, s36, 164224
buffer_load_dwordx4 v13, s[20:23], s35 offen nt lds
s_waitcnt lgkmcnt(4)
v_mfma_f32_16x16x32_bf16 v[68:71], v[40:43], v[132:135], 0
ds_read_b64_tr_b16 v[36:37], v4 offset:12288
v_mfma_f32_16x16x32_bf16 v[68:71], v[44:47], v[140:143], v[68:71]
ds_read_b64_tr_b16 v[38:39], v4 offset:14336
v_fma_f32 v183, v183, s37, -v16
v_exp_f32 v182, v182
v_cvt_pk_bf16_f32 v154, v180, v181
v_fma_f32 v184, v184, s37, -v17
v_exp_f32 v183, v183
v_mfma_f32_16x16x32_bf16 v[88:91], v[80:83], v[132:135], 0
v_mfma_f32_16x16x32_bf16 v[88:91], v[80:83], v[140:143], v[88:91]
v_fma_f32 v185, v185, s37, -v17
v_exp_f32 v184, v184
v_cvt_pk_bf16_f32 v155, v182, v183
v_fma_f32 v186, v186, s37, -v17
v_exp_f32 v185, v185
s_waitcnt lgkmcnt(4)
v_mfma_f32_16x16x32_bf16 v[60:63], v[24:27], v[128:131], 0
ds_read_b64_tr_b16 v[40:41], v5 offset:8192
v_mfma_f32_16x16x32_bf16 v[60:63], v[28:31], v[136:139], v[60:63]
ds_read_b64_tr_b16 v[42:43], v5 offset:10240
v_fma_f32 v187, v187, s37, -v17
v_exp_f32 v186, v186
v_cvt_pk_bf16_f32 v156, v184, v185
v_fma_f32 v188, v188, s37, -v17
v_exp_f32 v187, v187
v_fma_f32 v189, v189, s37, -v17
v_exp_f32 v188, v188
v_cvt_pk_bf16_f32 v157, v186, v187
v_fma_f32 v190, v190, s37, -v17
v_exp_f32 v189, v189
s_waitcnt lgkmcnt(4)
v_mfma_f32_16x16x32_bf16 v[76:79], v[24:27], v[132:135], 0
ds_read_b64_tr_b16 v[44:45], v5 offset:12288
v_mfma_f32_16x16x32_bf16 v[76:79], v[28:31], v[140:143], v[76:79]
ds_read_b64_tr_b16 v[46:47], v5 offset:14336
v_fma_f32 v191, v191, s37, -v17
v_exp_f32 v190, v190
v_cvt_pk_bf16_f32 v158, v188, v189
v_fma_f32 v192, v192, s37, -v16
v_exp_f32 v191, v191
v_fma_f32 v193, v193, s37, -v16
v_exp_f32 v192, v192
s_add_u32 m0, s32, 114688
s_xor_b32 s35, s36, 196992
buffer_load_dwordx4 v13, s[20:23], s35 offen nt lds
v_cvt_pk_bf16_f32 v159, v190, v191
v_fma_f32 v194, v194, s37, -v16
v_exp_f32 v193, v193
s_waitcnt lgkmcnt(4)
v_mfma_f32_16x16x32_bf16 v[48:51], v[32:35], v[144:147], v[48:51]
ds_read_b64_tr_b16 v[24:25], v6 offset:8192
v_mfma_f32_16x16x32_bf16 v[48:51], v[36:39], v[152:155], v[48:51]
ds_read_b64_tr_b16 v[26:27], v6 offset:10240
v_fma_f32 v195, v195, s37, -v16
v_exp_f32 v194, v194
v_cvt_pk_bf16_f32 v160, v192, v193
v_fma_f32 v196, v196, s37, -v16
v_exp_f32 v195, v195
v_fma_f32 v197, v197, s37, -v16
v_exp_f32 v196, v196
v_cvt_pk_bf16_f32 v161, v194, v195
v_fma_f32 v198, v198, s37, -v16
v_exp_f32 v197, v197
s_waitcnt lgkmcnt(4)
v_mfma_f32_16x16x32_bf16 v[64:67], v[32:35], v[148:151], v[64:67]
ds_read_b64_tr_b16 v[28:29], v6 offset:12288
v_mfma_f32_16x16x32_bf16 v[64:67], v[36:39], v[156:159], v[64:67]
ds_read_b64_tr_b16 v[30:31], v6 offset:14336
v_fma_f32 v199, v199, s37, -v16
v_exp_f32 v198, v198
v_cvt_pk_bf16_f32 v162, v196, v197
v_fma_f32 v200, v200, s37, -v17
v_exp_f32 v199, v199
v_fma_f32 v201, v201, s37, -v17
v_exp_f32 v200, v200
v_cvt_pk_bf16_f32 v163, v198, v199
v_fma_f32 v202, v202, s37, -v17
v_exp_f32 v201, v201
s_waitcnt lgkmcnt(4)
v_mfma_f32_16x16x32_bf16 v[56:59], v[40:43], v[144:147], v[56:59]
ds_read_b64_tr_b16 v[32:33], v7 offset:8192
v_mfma_f32_16x16x32_bf16 v[56:59], v[44:47], v[152:155], v[56:59]
ds_read_b64_tr_b16 v[34:35], v7 offset:10240
v_fma_f32 v203, v203, s37, -v17
v_exp_f32 v202, v202
v_cvt_pk_bf16_f32 v164, v200, v201
v_fma_f32 v204, v204, s37, -v17
v_exp_f32 v203, v203
v_mfma_f32_16x16x32_bf16 v[84:87], v[80:83], v[144:147], v[84:87]
v_mfma_f32_16x16x32_bf16 v[84:87], v[80:83], v[152:155], v[84:87]
v_fma_f32 v205, v205, s37, -v17
v_exp_f32 v204, v204
v_cvt_pk_bf16_f32 v165, v202, v203
v_fma_f32 v206, v206, s37, -v17
v_exp_f32 v205, v205
s_add_u32 m0, s32, 122880
s_xor_b32 s35, s36, 229760
buffer_load_dwordx4 v13, s[20:23], s35 offen nt lds
s_waitcnt lgkmcnt(4)
v_mfma_f32_16x16x32_bf16 v[72:75], v[40:43], v[148:151], v[72:75]
ds_read_b64_tr_b16 v[36:37], v7 offset:12288
v_mfma_f32_16x16x32_bf16 v[72:75], v[44:47], v[156:159], v[72:75]
ds_read_b64_tr_b16 v[38:39], v7 offset:14336
v_fma_f32 v207, v207, s37, -v17
v_exp_f32 v206, v206
v_cvt_pk_bf16_f32 v166, v204, v205
v_fma_f32 v208, v208, s37, -v16
v_exp_f32 v207, v207
v_fma_f32 v209, v209, s37, -v16
v_exp_f32 v208, v208
v_cvt_pk_bf16_f32 v167, v206, v207
v_fma_f32 v210, v210, s37, -v16
v_exp_f32 v209, v209
s_waitcnt lgkmcnt(4)
s_barrier
v_mfma_f32_16x16x32_bf16 v[52:55], v[24:27], v[144:147], v[52:55]
ds_read_b64_tr_b16 v[40:41], v4 offset:16384
v_mfma_f32_16x16x32_bf16 v[52:55], v[28:31], v[152:155], v[52:55]
ds_read_b64_tr_b16 v[42:43], v4 offset:18432
v_fma_f32 v211, v211, s37, -v16
v_exp_f32 v210, v210
v_cvt_pk_bf16_f32 v168, v208, v209
v_fma_f32 v212, v212, s37, -v16
v_exp_f32 v211, v211
v_fma_f32 v213, v213, s37, -v16
v_exp_f32 v212, v212
v_cvt_pk_bf16_f32 v169, v210, v211
v_fma_f32 v214, v214, s37, -v16
v_exp_f32 v213, v213
s_waitcnt lgkmcnt(4)
v_mfma_f32_16x16x32_bf16 v[68:71], v[24:27], v[148:151], v[68:71]
ds_read_b64_tr_b16 v[44:45], v4 offset:20480
v_mfma_f32_16x16x32_bf16 v[68:71], v[28:31], v[156:159], v[68:71]
ds_read_b64_tr_b16 v[46:47], v4 offset:22528
v_fma_f32 v215, v215, s37, -v16
v_exp_f32 v214, v214
v_cvt_pk_bf16_f32 v170, v212, v213
v_fma_f32 v216, v216, s37, -v17
v_exp_f32 v215, v215
v_mfma_f32_16x16x32_bf16 v[88:91], v[80:83], v[148:151], v[88:91]
v_mfma_f32_16x16x32_bf16 v[88:91], v[80:83], v[156:159], v[88:91]
v_fma_f32 v217, v217, s37, -v17
v_exp_f32 v216, v216
v_cvt_pk_bf16_f32 v171, v214, v215
v_fma_f32 v218, v218, s37, -v17
v_exp_f32 v217, v217
s_waitcnt lgkmcnt(4)
v_mfma_f32_16x16x32_bf16 v[60:63], v[32:35], v[144:147], v[60:63]
ds_read_b64_tr_b16 v[24:25], v5 offset:16384
v_mfma_f32_16x16x32_bf16 v[60:63], v[36:39], v[152:155], v[60:63]
ds_read_b64_tr_b16 v[26:27], v5 offset:18432
v_fma_f32 v219, v219, s37, -v17
v_exp_f32 v218, v218
v_cvt_pk_bf16_f32 v172, v216, v217
v_fma_f32 v220, v220, s37, -v17
v_exp_f32 v219, v219
v_fma_f32 v221, v221, s37, -v17
v_exp_f32 v220, v220
v_cvt_pk_bf16_f32 v173, v218, v219
v_fma_f32 v222, v222, s37, -v17
v_exp_f32 v221, v221
s_waitcnt lgkmcnt(4)
v_mfma_f32_16x16x32_bf16 v[76:79], v[32:35], v[148:151], v[76:79]
ds_read_b64_tr_b16 v[28:29], v5 offset:20480
v_mfma_f32_16x16x32_bf16 v[76:79], v[36:39], v[156:159], v[76:79]
ds_read_b64_tr_b16 v[30:31], v5 offset:22528
v_fma_f32 v223, v223, s37, -v17
v_exp_f32 v222, v222
v_cvt_pk_bf16_f32 v174, v220, v221
v_fma_f32 v224, v224, s37, -v16
v_exp_f32 v223, v223
v_fma_f32 v225, v225, s37, -v16
v_exp_f32 v224, v224
v_cvt_pk_bf16_f32 v175, v222, v223
v_fma_f32 v226, v226, s37, -v16
v_exp_f32 v225, v225
s_waitcnt lgkmcnt(4)
v_mfma_f32_16x16x32_bf16 v[48:51], v[40:43], v[160:163], v[48:51]
ds_read_b64_tr_b16 v[32:33], v6 offset:16384
v_mfma_f32_16x16x32_bf16 v[48:51], v[44:47], v[168:171], v[48:51]
ds_read_b64_tr_b16 v[34:35], v6 offset:18432
v_fma_f32 v227, v227, s37, -v16
v_exp_f32 v226, v226
v_cvt_pk_bf16_f32 v176, v224, v225
v_fma_f32 v228, v228, s37, -v16
v_exp_f32 v227, v227
v_fma_f32 v229, v229, s37, -v16
v_exp_f32 v228, v228
v_cvt_pk_bf16_f32 v177, v226, v227
v_fma_f32 v230, v230, s37, -v16
v_exp_f32 v229, v229
s_waitcnt lgkmcnt(4)
v_mfma_f32_16x16x32_bf16 v[64:67], v[40:43], v[164:167], v[64:67]
ds_read_b64_tr_b16 v[36:37], v6 offset:20480
v_mfma_f32_16x16x32_bf16 v[64:67], v[44:47], v[172:175], v[64:67]
ds_read_b64_tr_b16 v[38:39], v6 offset:22528
v_fma_f32 v231, v231, s37, -v16
v_exp_f32 v230, v230
v_cvt_pk_bf16_f32 v178, v228, v229
v_fma_f32 v232, v232, s37, -v17
v_exp_f32 v231, v231
v_fma_f32 v233, v233, s37, -v17
v_exp_f32 v232, v232
v_cvt_pk_bf16_f32 v179, v230, v231
v_fma_f32 v234, v234, s37, -v17
v_exp_f32 v233, v233
s_waitcnt lgkmcnt(4)
v_mfma_f32_16x16x32_bf16 v[56:59], v[24:27], v[160:163], v[56:59]
ds_read_b64_tr_b16 v[40:41], v7 offset:16384
v_mfma_f32_16x16x32_bf16 v[56:59], v[28:31], v[168:171], v[56:59]
ds_read_b64_tr_b16 v[42:43], v7 offset:18432
v_fma_f32 v235, v235, s37, -v17
v_exp_f32 v234, v234
v_cvt_pk_bf16_f32 v180, v232, v233
v_fma_f32 v236, v236, s37, -v17
v_exp_f32 v235, v235
v_mfma_f32_16x16x32_bf16 v[84:87], v[80:83], v[160:163], v[84:87]
v_mfma_f32_16x16x32_bf16 v[84:87], v[80:83], v[168:171], v[84:87]
v_fma_f32 v237, v237, s37, -v17
v_exp_f32 v236, v236
v_cvt_pk_bf16_f32 v181, v234, v235
v_fma_f32 v238, v238, s37, -v17
v_exp_f32 v237, v237
s_waitcnt lgkmcnt(4)
v_mfma_f32_16x16x32_bf16 v[72:75], v[24:27], v[164:167], v[72:75]
ds_read_b64_tr_b16 v[44:45], v7 offset:20480
v_mfma_f32_16x16x32_bf16 v[72:75], v[28:31], v[172:175], v[72:75]
ds_read_b64_tr_b16 v[46:47], v7 offset:22528
v_fma_f32 v239, v239, s37, -v17
v_exp_f32 v238, v238
v_cvt_pk_bf16_f32 v182, v236, v237
v_fma_f32 v240, v240, s37, -v16
v_exp_f32 v239, v239
v_fma_f32 v241, v241, s37, -v16
v_exp_f32 v240, v240
v_cvt_pk_bf16_f32 v183, v238, v239
v_fma_f32 v242, v242, s37, -v16
v_exp_f32 v241, v241
s_waitcnt lgkmcnt(4)
v_mfma_f32_16x16x32_bf16 v[52:55], v[32:35], v[160:163], v[52:55]
ds_read_b64_tr_b16 v[24:25], v4 offset:24576
v_mfma_f32_16x16x32_bf16 v[52:55], v[36:39], v[168:171], v[52:55]
ds_read_b64_tr_b16 v[26:27], v4 offset:26624
v_fma_f32 v243, v243, s37, -v16
v_exp_f32 v242, v242
v_cvt_pk_bf16_f32 v184, v240, v241
v_fma_f32 v244, v244, s37, -v16
v_exp_f32 v243, v243
v_fma_f32 v245, v245, s37, -v16
v_exp_f32 v244, v244
v_cvt_pk_bf16_f32 v185, v242, v243
v_fma_f32 v246, v246, s37, -v16
v_exp_f32 v245, v245
s_waitcnt lgkmcnt(4)
v_mfma_f32_16x16x32_bf16 v[68:71], v[32:35], v[164:167], v[68:71]
ds_read_b64_tr_b16 v[28:29], v4 offset:28672
v_mfma_f32_16x16x32_bf16 v[68:71], v[36:39], v[172:175], v[68:71]
ds_read_b64_tr_b16 v[30:31], v4 offset:30720
v_fma_f32 v247, v247, s37, -v16
v_exp_f32 v246, v246
v_cvt_pk_bf16_f32 v186, v244, v245
v_fma_f32 v248, v248, s37, -v17
v_exp_f32 v247, v247
v_mfma_f32_16x16x32_bf16 v[88:91], v[80:83], v[164:167], v[88:91]
v_mfma_f32_16x16x32_bf16 v[88:91], v[80:83], v[172:175], v[88:91]
v_fma_f32 v249, v249, s37, -v17
v_exp_f32 v248, v248
v_cvt_pk_bf16_f32 v187, v246, v247
v_fma_f32 v250, v250, s37, -v17
v_exp_f32 v249, v249
s_waitcnt lgkmcnt(4)
v_mfma_f32_16x16x32_bf16 v[60:63], v[40:43], v[160:163], v[60:63]
ds_read_b64_tr_b16 v[32:33], v5 offset:24576
v_mfma_f32_16x16x32_bf16 v[60:63], v[44:47], v[168:171], v[60:63]
ds_read_b64_tr_b16 v[34:35], v5 offset:26624
v_fma_f32 v251, v251, s37, -v17
v_exp_f32 v250, v250
v_cvt_pk_bf16_f32 v188, v248, v249
v_fma_f32 v252, v252, s37, -v17
v_exp_f32 v251, v251
v_fma_f32 v253, v253, s37, -v17
v_exp_f32 v252, v252
v_cvt_pk_bf16_f32 v189, v250, v251
v_fma_f32 v254, v254, s37, -v17
v_exp_f32 v253, v253
s_waitcnt lgkmcnt(4)
v_mfma_f32_16x16x32_bf16 v[76:79], v[40:43], v[164:167], v[76:79]
ds_read_b64_tr_b16 v[36:37], v5 offset:28672
v_mfma_f32_16x16x32_bf16 v[76:79], v[44:47], v[172:175], v[76:79]
ds_read_b64_tr_b16 v[38:39], v5 offset:30720
v_fma_f32 v255, v255, s37, -v17
v_exp_f32 v254, v254
v_cvt_pk_bf16_f32 v190, v252, v253
v_exp_f32 v255, v255
s_nop 0
v_cvt_pk_bf16_f32 v191, v254, v255
s_nop 0
s_nop 0
s_waitcnt lgkmcnt(4)
v_mfma_f32_16x16x32_bf16 v[48:51], v[24:27], v[176:179], v[48:51]
ds_read_b64_tr_b16 v[40:41], v6 offset:24576
v_mfma_f32_16x16x32_bf16 v[48:51], v[28:31], v[184:187], v[48:51]
ds_read_b64_tr_b16 v[42:43], v6 offset:26624
s_waitcnt lgkmcnt(4)
v_mfma_f32_16x16x32_bf16 v[64:67], v[24:27], v[180:183], v[64:67]
ds_read_b64_tr_b16 v[44:45], v6 offset:28672
v_mfma_f32_16x16x32_bf16 v[64:67], v[28:31], v[188:191], v[64:67]
ds_read_b64_tr_b16 v[46:47], v6 offset:30720
s_waitcnt lgkmcnt(4)
v_mfma_f32_16x16x32_bf16 v[56:59], v[32:35], v[176:179], v[56:59]
ds_read_b64_tr_b16 v[24:25], v7 offset:24576
v_mfma_f32_16x16x32_bf16 v[56:59], v[36:39], v[184:187], v[56:59]
ds_read_b64_tr_b16 v[26:27], v7 offset:26624
v_mfma_f32_16x16x32_bf16 v[84:87], v[80:83], v[176:179], v[84:87]
v_mfma_f32_16x16x32_bf16 v[84:87], v[80:83], v[184:187], v[84:87]
s_waitcnt lgkmcnt(4)
v_mfma_f32_16x16x32_bf16 v[72:75], v[32:35], v[180:183], v[72:75]
ds_read_b64_tr_b16 v[28:29], v7 offset:28672
v_mfma_f32_16x16x32_bf16 v[72:75], v[36:39], v[188:191], v[72:75]
ds_read_b64_tr_b16 v[30:31], v7 offset:30720
buffer_store_dwordx4 v[96:99], v14, s[24:27], s76 offen offset:0 sc1
s_waitcnt lgkmcnt(4)
s_barrier
v_mfma_f32_16x16x32_bf16 v[52:55], v[40:43], v[176:179], v[52:55]
ds_read_b64_tr_b16 v[32:33], v4 offset:32768
v_mfma_f32_16x16x32_bf16 v[52:55], v[44:47], v[184:187], v[52:55]
ds_read_b64_tr_b16 v[34:35], v4 offset:34816
s_waitcnt lgkmcnt(4)
v_mfma_f32_16x16x32_bf16 v[68:71], v[40:43], v[180:183], v[68:71]
ds_read_b64_tr_b16 v[36:37], v4 offset:36864
v_mfma_f32_16x16x32_bf16 v[68:71], v[44:47], v[188:191], v[68:71]
ds_read_b64_tr_b16 v[38:39], v4 offset:38912
v_mfma_f32_16x16x32_bf16 v[88:91], v[80:83], v[180:183], v[88:91]
v_mfma_f32_16x16x32_bf16 v[88:91], v[80:83], v[188:191], v[88:91]
s_waitcnt lgkmcnt(4)
v_mfma_f32_16x16x32_bf16 v[60:63], v[24:27], v[176:179], v[60:63]
ds_read_b64_tr_b16 v[40:41], v4 offset:40960
v_mfma_f32_16x16x32_bf16 v[60:63], v[28:31], v[184:187], v[60:63]
ds_read_b64_tr_b16 v[42:43], v4 offset:43008
s_waitcnt lgkmcnt(4)
v_mfma_f32_16x16x32_bf16 v[76:79], v[24:27], v[180:183], v[76:79]
ds_read_b64_tr_b16 v[44:45], v4 offset:45056
v_mfma_f32_16x16x32_bf16 v[76:79], v[28:31], v[188:191], v[76:79]
ds_read_b64_tr_b16 v[46:47], v4 offset:47104
s_waitcnt lgkmcnt(0)
v_mfma_f32_16x16x32_bf16 v[192:195], v[32:35], v[128:131], 0
v_mfma_f32_16x16x32_bf16 v[192:195], v[36:39], v[136:139], v[192:195]
v_mfma_f32_16x16x32_bf16 v[192:195], v[40:43], v[144:147], v[192:195]
v_mfma_f32_16x16x32_bf16 v[192:195], v[44:47], v[152:155], v[192:195]
buffer_store_dwordx4 v[100:103], v14, s[24:27], s76 offen offset:512 sc1
v_mfma_f32_16x16x32_bf16 v[208:211], v[32:35], v[132:135], 0
v_mfma_f32_16x16x32_bf16 v[208:211], v[36:39], v[140:143], v[208:211]
v_mfma_f32_16x16x32_bf16 v[208:211], v[40:43], v[148:151], v[208:211]
v_mfma_f32_16x16x32_bf16 v[208:211], v[44:47], v[156:159], v[208:211]
v_rcp_f32 v18, v84
v_rcp_f32 v20, v88
v_mul_f32 v48, v18, v48
v_mul_f32 v49, v18, v49
ds_read_b64_tr_b16 v[24:25], v6 offset:32768
ds_read_b64_tr_b16 v[26:27], v6 offset:34816
ds_read_b64_tr_b16 v[28:29], v6 offset:36864
ds_read_b64_tr_b16 v[30:31], v6 offset:38912
ds_read_b64_tr_b16 v[32:33], v6 offset:40960
ds_read_b64_tr_b16 v[34:35], v6 offset:43008
ds_read_b64_tr_b16 v[36:37], v6 offset:45056
ds_read_b64_tr_b16 v[38:39], v6 offset:47104
s_waitcnt lgkmcnt(0)
v_mfma_f32_16x16x32_bf16 v[196:199], v[24:27], v[128:131], 0
v_mfma_f32_16x16x32_bf16 v[196:199], v[28:31], v[136:139], v[196:199]
v_mfma_f32_16x16x32_bf16 v[196:199], v[32:35], v[144:147], v[196:199]
v_mfma_f32_16x16x32_bf16 v[196:199], v[36:39], v[152:155], v[196:199]
v_mul_f32 v50, v18, v50
v_mul_f32 v51, v18, v51
v_mul_f32 v52, v18, v52
v_mul_f32 v53, v18, v53
v_mul_f32 v54, v18, v54
v_mul_f32 v55, v18, v55
v_cvt_pk_bf16_f32 v48, v48, v49
v_cvt_pk_bf16_f32 v49, v50, v51
buffer_store_dwordx4 v[104:107], v14, s[24:27], s77 offen offset:0 sc1
v_mfma_f32_16x16x32_bf16 v[212:215], v[24:27], v[132:135], 0
v_mfma_f32_16x16x32_bf16 v[212:215], v[28:31], v[140:143], v[212:215]
v_mfma_f32_16x16x32_bf16 v[212:215], v[32:35], v[148:151], v[212:215]
v_mfma_f32_16x16x32_bf16 v[212:215], v[36:39], v[156:159], v[212:215]
v_cvt_pk_bf16_f32 v50, v52, v53
v_cvt_pk_bf16_f32 v51, v54, v55
v_mul_f32 v56, v18, v56
v_mul_f32 v57, v18, v57
v_mul_f32 v58, v18, v58
v_permlane16_swap_b32 v48, v50
ds_read_b64_tr_b16 v[40:41], v5 offset:32768
ds_read_b64_tr_b16 v[42:43], v5 offset:34816
ds_read_b64_tr_b16 v[44:45], v5 offset:36864
ds_read_b64_tr_b16 v[46:47], v5 offset:38912
ds_read_b64_tr_b16 v[24:25], v5 offset:40960
ds_read_b64_tr_b16 v[26:27], v5 offset:43008
ds_read_b64_tr_b16 v[28:29], v5 offset:45056
ds_read_b64_tr_b16 v[30:31], v5 offset:47104
s_waitcnt lgkmcnt(0)
v_mfma_f32_16x16x32_bf16 v[200:203], v[40:43], v[128:131], 0
v_mfma_f32_16x16x32_bf16 v[200:203], v[44:47], v[136:139], v[200:203]
v_mfma_f32_16x16x32_bf16 v[200:203], v[24:27], v[144:147], v[200:203]
v_mfma_f32_16x16x32_bf16 v[200:203], v[28:31], v[152:155], v[200:203]
v_mul_f32 v59, v18, v59
v_mul_f32 v60, v18, v60
v_mul_f32 v61, v18, v61
v_mul_f32 v62, v18, v62
v_mul_f32 v63, v18, v63
v_permlane16_swap_b32 v49, v51
v_mfma_f32_16x16x32_bf16 v[216:219], v[40:43], v[132:135], 0
v_mfma_f32_16x16x32_bf16 v[216:219], v[44:47], v[140:143], v[216:219]
v_mfma_f32_16x16x32_bf16 v[216:219], v[24:27], v[148:151], v[216:219]
v_mfma_f32_16x16x32_bf16 v[216:219], v[28:31], v[156:159], v[216:219]
v_cvt_pk_bf16_f32 v52, v56, v57
v_cvt_pk_bf16_f32 v53, v58, v59
v_cvt_pk_bf16_f32 v54, v60, v61
v_cvt_pk_bf16_f32 v55, v62, v63
v_mul_f32 v64, v20, v64
v_mul_f32 v65, v20, v65
buffer_store_dwordx4 v[108:111], v14, s[24:27], s77 offen offset:512 sc1
ds_read_b64_tr_b16 v[32:33], v7 offset:32768
ds_read_b64_tr_b16 v[34:35], v7 offset:34816
ds_read_b64_tr_b16 v[36:37], v7 offset:36864
ds_read_b64_tr_b16 v[38:39], v7 offset:38912
ds_read_b64_tr_b16 v[40:41], v7 offset:40960
ds_read_b64_tr_b16 v[42:43], v7 offset:43008
ds_read_b64_tr_b16 v[44:45], v7 offset:45056
ds_read_b64_tr_b16 v[46:47], v7 offset:47104
s_waitcnt lgkmcnt(0)
s_waitcnt vmcnt(12)
s_barrier
v_mfma_f32_16x16x32_bf16 v[204:207], v[32:35], v[128:131], 0
v_mfma_f32_16x16x32_bf16 v[204:207], v[36:39], v[136:139], v[204:207]
v_mfma_f32_16x16x32_bf16 v[204:207], v[40:43], v[144:147], v[204:207]
v_mfma_f32_16x16x32_bf16 v[204:207], v[44:47], v[152:155], v[204:207]
v_mul_f32 v66, v20, v66
v_permlane16_swap_b32 v52, v54
v_mul_f32 v67, v20, v67
v_permlane16_swap_b32 v53, v55
v_mfma_f32_16x16x32_bf16 v[220:223], v[32:35], v[132:135], 0
v_mfma_f32_16x16x32_bf16 v[220:223], v[36:39], v[140:143], v[220:223]
v_mfma_f32_16x16x32_bf16 v[220:223], v[40:43], v[148:151], v[220:223]
v_mfma_f32_16x16x32_bf16 v[220:223], v[44:47], v[156:159], v[220:223]
v_mul_f32 v68, v20, v68
s_mov_b64 vcc, s[62:63]
v_cndmask_b32_dpp v80, v52, v48, vcc quad_perm:[1,0,3,2] row_mask:0xf bank_mask:0xf
v_mul_f32 v69, v20, v69
v_cndmask_b32_dpp v82, v54, v50, vcc quad_perm:[1,0,3,2] row_mask:0xf bank_mask:0xf
v_mul_f32 v70, v20, v70
v_cndmask_b32_dpp v81, v53, v49, vcc quad_perm:[1,0,3,2] row_mask:0xf bank_mask:0xf
v_mul_f32 v71, v20, v71
buffer_store_dwordx4 v[112:115], v14, s[24:27], s78 offen offset:0 sc1
ds_read_b64_tr_b16 v[24:25], v4 offset:49152
ds_read_b64_tr_b16 v[26:27], v4 offset:51200
ds_read_b64_tr_b16 v[28:29], v4 offset:53248
ds_read_b64_tr_b16 v[30:31], v4 offset:55296
ds_read_b64_tr_b16 v[32:33], v4 offset:57344
ds_read_b64_tr_b16 v[34:35], v4 offset:59392
ds_read_b64_tr_b16 v[36:37], v4 offset:61440
ds_read_b64_tr_b16 v[38:39], v4 offset:63488
s_waitcnt lgkmcnt(0)
v_mfma_f32_16x16x32_bf16 v[192:195], v[24:27], v[160:163], v[192:195]
v_mfma_f32_16x16x32_bf16 v[192:195], v[28:31], v[168:171], v[192:195]
v_mfma_f32_16x16x32_bf16 v[192:195], v[32:35], v[176:179], v[192:195]
v_mfma_f32_16x16x32_bf16 v[192:195], v[36:39], v[184:187], v[192:195]
v_cndmask_b32_dpp v83, v55, v51, vcc quad_perm:[1,0,3,2] row_mask:0xf bank_mask:0xf
v_cvt_pk_bf16_f32 v64, v64, v65
v_cvt_pk_bf16_f32 v65, v66, v67
v_cvt_pk_bf16_f32 v66, v68, v69
v_cvt_pk_bf16_f32 v67, v70, v71
v_mul_f32 v72, v20, v72
s_not_b64 vcc, vcc
v_cndmask_b32_dpp v84, v48, v52, vcc quad_perm:[1,0,3,2] row_mask:0xf bank_mask:0xf
v_mfma_f32_16x16x32_bf16 v[208:211], v[24:27], v[164:167], v[208:211]
v_mfma_f32_16x16x32_bf16 v[208:211], v[28:31], v[172:175], v[208:211]
v_mfma_f32_16x16x32_bf16 v[208:211], v[32:35], v[180:183], v[208:211]
v_mfma_f32_16x16x32_bf16 v[208:211], v[36:39], v[188:191], v[208:211]
v_mul_f32 v73, v20, v73
v_cndmask_b32_dpp v86, v50, v54, vcc quad_perm:[1,0,3,2] row_mask:0xf bank_mask:0xf
v_mul_f32 v74, v20, v74
v_cndmask_b32_dpp v85, v49, v53, vcc quad_perm:[1,0,3,2] row_mask:0xf bank_mask:0xf
v_mul_f32 v75, v20, v75
v_cndmask_b32_dpp v87, v51, v55, vcc quad_perm:[1,0,3,2] row_mask:0xf bank_mask:0xf
v_mul_f32 v76, v20, v76
ds_read_b64_tr_b16 v[40:41], v6 offset:49152
ds_read_b64_tr_b16 v[42:43], v6 offset:51200
ds_read_b64_tr_b16 v[44:45], v6 offset:53248
ds_read_b64_tr_b16 v[46:47], v6 offset:55296
ds_read_b64_tr_b16 v[24:25], v6 offset:57344
ds_read_b64_tr_b16 v[26:27], v6 offset:59392
ds_read_b64_tr_b16 v[28:29], v6 offset:61440
ds_read_b64_tr_b16 v[30:31], v6 offset:63488
s_waitcnt lgkmcnt(0)
v_mfma_f32_16x16x32_bf16 v[196:199], v[40:43], v[160:163], v[196:199]
v_mfma_f32_16x16x32_bf16 v[196:199], v[44:47], v[168:171], v[196:199]
v_mfma_f32_16x16x32_bf16 v[196:199], v[24:27], v[176:179], v[196:199]
v_mfma_f32_16x16x32_bf16 v[196:199], v[28:31], v[184:187], v[196:199]
v_mul_f32 v77, v20, v77
v_permlane16_swap_b32 v64, v66
v_mul_f32 v78, v20, v78
v_permlane16_swap_b32 v65, v67
buffer_store_dwordx4 v[116:119], v14, s[24:27], s78 offen offset:512 sc1
v_mfma_f32_16x16x32_bf16 v[212:215], v[40:43], v[164:167], v[212:215]
v_mfma_f32_16x16x32_bf16 v[212:215], v[44:47], v[172:175], v[212:215]
v_mfma_f32_16x16x32_bf16 v[212:215], v[24:27], v[180:183], v[212:215]
v_mfma_f32_16x16x32_bf16 v[212:215], v[28:31], v[188:191], v[212:215]
v_mul_f32 v79, v20, v79
v_cvt_pk_bf16_f32 v68, v72, v73
v_cvt_pk_bf16_f32 v69, v74, v75
v_cvt_pk_bf16_f32 v70, v76, v77
v_cvt_pk_bf16_f32 v71, v78, v79
s_nop 0
ds_read_b64_tr_b16 v[32:33], v5 offset:49152
ds_read_b64_tr_b16 v[34:35], v5 offset:51200
ds_read_b64_tr_b16 v[36:37], v5 offset:53248
ds_read_b64_tr_b16 v[38:39], v5 offset:55296
ds_read_b64_tr_b16 v[40:41], v5 offset:57344
ds_read_b64_tr_b16 v[42:43], v5 offset:59392
ds_read_b64_tr_b16 v[44:45], v5 offset:61440
ds_read_b64_tr_b16 v[46:47], v5 offset:63488
s_waitcnt lgkmcnt(0)
v_mfma_f32_16x16x32_bf16 v[200:203], v[32:35], v[160:163], v[200:203]
v_mfma_f32_16x16x32_bf16 v[200:203], v[36:39], v[168:171], v[200:203]
v_mfma_f32_16x16x32_bf16 v[200:203], v[40:43], v[176:179], v[200:203]
v_mfma_f32_16x16x32_bf16 v[200:203], v[44:47], v[184:187], v[200:203]
v_permlane16_swap_b32 v68, v70
v_permlane16_swap_b32 v69, v71
buffer_store_dwordx4 v[120:123], v14, s[24:27], s79 offen offset:0 sc1
v_mfma_f32_16x16x32_bf16 v[216:219], v[32:35], v[164:167], v[216:219]
v_mfma_f32_16x16x32_bf16 v[216:219], v[36:39], v[172:175], v[216:219]
v_mfma_f32_16x16x32_bf16 v[216:219], v[40:43], v[180:183], v[216:219]
v_mfma_f32_16x16x32_bf16 v[216:219], v[44:47], v[188:191], v[216:219]
s_not_b64 vcc, vcc
s_nop 0
v_cndmask_b32_dpp v88, v68, v64, vcc quad_perm:[1,0,3,2] row_mask:0xf bank_mask:0xf
v_cndmask_b32_dpp v90, v70, v66, vcc quad_perm:[1,0,3,2] row_mask:0xf bank_mask:0xf
v_cndmask_b32_dpp v89, v69, v65, vcc quad_perm:[1,0,3,2] row_mask:0xf bank_mask:0xf
v_cndmask_b32_dpp v91, v71, v67, vcc quad_perm:[1,0,3,2] row_mask:0xf bank_mask:0xf
s_not_b64 vcc, vcc
v_cndmask_b32_dpp v92, v64, v68, vcc quad_perm:[1,0,3,2] row_mask:0xf bank_mask:0xf
ds_read_b64_tr_b16 v[24:25], v7 offset:49152
ds_read_b64_tr_b16 v[26:27], v7 offset:51200
ds_read_b64_tr_b16 v[28:29], v7 offset:53248
ds_read_b64_tr_b16 v[30:31], v7 offset:55296
ds_read_b64_tr_b16 v[32:33], v7 offset:57344
ds_read_b64_tr_b16 v[34:35], v7 offset:59392
ds_read_b64_tr_b16 v[36:37], v7 offset:61440
ds_read_b64_tr_b16 v[38:39], v7 offset:63488
s_waitcnt lgkmcnt(0)
s_waitcnt vmcnt(13)
s_barrier
v_mfma_f32_16x16x32_bf16 v[204:207], v[24:27], v[160:163], v[204:207]
v_mfma_f32_16x16x32_bf16 v[204:207], v[28:31], v[168:171], v[204:207]
v_mfma_f32_16x16x32_bf16 v[204:207], v[32:35], v[176:179], v[204:207]
v_mfma_f32_16x16x32_bf16 v[204:207], v[36:39], v[184:187], v[204:207]
v_cndmask_b32_dpp v94, v66, v70, vcc quad_perm:[1,0,3,2] row_mask:0xf bank_mask:0xf
v_cndmask_b32_dpp v93, v65, v69, vcc quad_perm:[1,0,3,2] row_mask:0xf bank_mask:0xf
v_cndmask_b32_dpp v95, v67, v71, vcc quad_perm:[1,0,3,2] row_mask:0xf bank_mask:0xf
v_mul_f32 v192, v18, v192
v_mul_f32 v193, v18, v193
v_mul_f32 v194, v18, v194
v_mul_f32 v195, v18, v195
v_mfma_f32_16x16x32_bf16 v[220:223], v[24:27], v[164:167], v[220:223]
v_mfma_f32_16x16x32_bf16 v[220:223], v[28:31], v[172:175], v[220:223]
v_mfma_f32_16x16x32_bf16 v[220:223], v[32:35], v[180:183], v[220:223]
v_mfma_f32_16x16x32_bf16 v[220:223], v[36:39], v[188:191], v[220:223]
v_mul_f32 v196, v18, v196
v_mul_f32 v197, v18, v197
v_mul_f32 v198, v18, v198
v_mul_f32 v199, v18, v199
v_cvt_pk_bf16_f32 v192, v192, v193
v_cvt_pk_bf16_f32 v193, v194, v195
v_cvt_pk_bf16_f32 v194, v196, v197
v_cvt_pk_bf16_f32 v195, v198, v199
buffer_store_dwordx4 v[124:127], v14, s[24:27], s79 offen offset:512 sc1
v_xor_b32 v4, 0x10000, v4
v_xor_b32 v5, 0x10000, v5
v_xor_b32 v6, 0x10000, v6
v_xor_b32 v7, 0x10000, v7
ds_read_b64_tr_b16 v[40:41], v4 offset:0
ds_read_b64_tr_b16 v[42:43], v4 offset:2048
ds_read_b64_tr_b16 v[44:45], v4 offset:4096
ds_read_b64_tr_b16 v[46:47], v4 offset:6144
ds_read_b64_tr_b16 v[24:25], v4 offset:8192
ds_read_b64_tr_b16 v[26:27], v4 offset:10240
ds_read_b64_tr_b16 v[28:29], v4 offset:12288
ds_read_b64_tr_b16 v[30:31], v4 offset:14336
s_waitcnt lgkmcnt(0)
v_mfma_f32_16x16x32_bf16 v[224:227], v[40:43], v[128:131], 0
v_mfma_f32_16x16x32_bf16 v[224:227], v[44:47], v[136:139], v[224:227]
v_mfma_f32_16x16x32_bf16 v[224:227], v[24:27], v[144:147], v[224:227]
v_mfma_f32_16x16x32_bf16 v[224:227], v[28:31], v[152:155], v[224:227]
v_mul_f32 v208, v20, v208
v_mul_f32 v209, v20, v209
v_mul_f32 v210, v20, v210
v_permlane16_swap_b32 v192, v194
v_mfma_f32_16x16x32_bf16 v[240:243], v[40:43], v[132:135], 0
v_mfma_f32_16x16x32_bf16 v[240:243], v[44:47], v[140:143], v[240:243]
v_mfma_f32_16x16x32_bf16 v[240:243], v[24:27], v[148:151], v[240:243]
v_mfma_f32_16x16x32_bf16 v[240:243], v[28:31], v[156:159], v[240:243]
v_mul_f32 v211, v20, v211
v_mul_f32 v212, v20, v212
v_mul_f32 v213, v20, v213
v_mul_f32 v214, v20, v214
v_mul_f32 v215, v20, v215
v_permlane16_swap_b32 v193, v195
buffer_store_dwordx4 v[80:83], v14, s[24:27], s80 offen offset:0 sc1
ds_read_b64_tr_b16 v[32:33], v6 offset:0
ds_read_b64_tr_b16 v[34:35], v6 offset:2048
ds_read_b64_tr_b16 v[36:37], v6 offset:4096
ds_read_b64_tr_b16 v[38:39], v6 offset:6144
ds_read_b64_tr_b16 v[40:41], v6 offset:8192
ds_read_b64_tr_b16 v[42:43], v6 offset:10240
ds_read_b64_tr_b16 v[44:45], v6 offset:12288
ds_read_b64_tr_b16 v[46:47], v6 offset:14336
s_waitcnt lgkmcnt(0)
v_mfma_f32_16x16x32_bf16 v[228:231], v[32:35], v[128:131], 0
v_mfma_f32_16x16x32_bf16 v[228:231], v[36:39], v[136:139], v[228:231]
v_mfma_f32_16x16x32_bf16 v[228:231], v[40:43], v[144:147], v[228:231]
v_mfma_f32_16x16x32_bf16 v[228:231], v[44:47], v[152:155], v[228:231]
v_cvt_pk_bf16_f32 v208, v208, v209
v_cvt_pk_bf16_f32 v209, v210, v211
v_cvt_pk_bf16_f32 v210, v212, v213
v_cvt_pk_bf16_f32 v211, v214, v215
s_nop 0
v_permlane16_swap_b32 v208, v210
v_mfma_f32_16x16x32_bf16 v[244:247], v[32:35], v[132:135], 0
v_mfma_f32_16x16x32_bf16 v[244:247], v[36:39], v[140:143], v[244:247]
v_mfma_f32_16x16x32_bf16 v[244:247], v[40:43], v[148:151], v[244:247]
v_mfma_f32_16x16x32_bf16 v[244:247], v[44:47], v[156:159], v[244:247]
v_permlane16_swap_b32 v209, v211
v_mul_f32 v200, v18, v200
v_mul_f32 v201, v18, v201
v_mul_f32 v202, v18, v202
v_mul_f32 v203, v18, v203
buffer_store_dwordx4 v[84:87], v14, s[24:27], s80 offen offset:512 sc1
ds_read_b64_tr_b16 v[24:25], v5 offset:0
ds_read_b64_tr_b16 v[26:27], v5 offset:2048
ds_read_b64_tr_b16 v[28:29], v5 offset:4096
ds_read_b64_tr_b16 v[30:31], v5 offset:6144
ds_read_b64_tr_b16 v[32:33], v5 offset:8192
ds_read_b64_tr_b16 v[34:35], v5 offset:10240
ds_read_b64_tr_b16 v[36:37], v5 offset:12288
ds_read_b64_tr_b16 v[38:39], v5 offset:14336
s_waitcnt lgkmcnt(0)
v_mfma_f32_16x16x32_bf16 v[232:235], v[24:27], v[128:131], 0
v_mfma_f32_16x16x32_bf16 v[232:235], v[28:31], v[136:139], v[232:235]
v_mfma_f32_16x16x32_bf16 v[232:235], v[32:35], v[144:147], v[232:235]
v_mfma_f32_16x16x32_bf16 v[232:235], v[36:39], v[152:155], v[232:235]
v_mul_f32 v204, v18, v204
v_mul_f32 v205, v18, v205
v_mul_f32 v206, v18, v206
v_mul_f32 v207, v18, v207
v_cvt_pk_bf16_f32 v196, v200, v201
v_cvt_pk_bf16_f32 v197, v202, v203
v_cvt_pk_bf16_f32 v198, v204, v205
v_cvt_pk_bf16_f32 v199, v206, v207
v_mfma_f32_16x16x32_bf16 v[248:251], v[24:27], v[132:135], 0
v_mfma_f32_16x16x32_bf16 v[248:251], v[28:31], v[140:143], v[248:251]
v_mfma_f32_16x16x32_bf16 v[248:251], v[32:35], v[148:151], v[248:251]
v_mfma_f32_16x16x32_bf16 v[248:251], v[36:39], v[156:159], v[248:251]
v_mul_f32 v216, v20, v216
v_mul_f32 v217, v20, v217
v_mul_f32 v218, v20, v218
v_permlane16_swap_b32 v196, v198
ds_read_b64_tr_b16 v[40:41], v7 offset:0
ds_read_b64_tr_b16 v[42:43], v7 offset:2048
ds_read_b64_tr_b16 v[44:45], v7 offset:4096
ds_read_b64_tr_b16 v[46:47], v7 offset:6144
ds_read_b64_tr_b16 v[24:25], v7 offset:8192
ds_read_b64_tr_b16 v[26:27], v7 offset:10240
ds_read_b64_tr_b16 v[28:29], v7 offset:12288
ds_read_b64_tr_b16 v[30:31], v7 offset:14336
s_waitcnt lgkmcnt(0)
s_waitcnt vmcnt(14)
s_barrier
v_mfma_f32_16x16x32_bf16 v[236:239], v[40:43], v[128:131], 0
v_mfma_f32_16x16x32_bf16 v[236:239], v[44:47], v[136:139], v[236:239]
v_mfma_f32_16x16x32_bf16 v[236:239], v[24:27], v[144:147], v[236:239]
v_mfma_f32_16x16x32_bf16 v[236:239], v[28:31], v[152:155], v[236:239]
v_mul_f32 v219, v20, v219
v_permlane16_swap_b32 v197, v199
v_mul_f32 v220, v20, v220
s_mov_b64 vcc, s[62:63]
v_cndmask_b32_dpp v64, v196, v192, vcc quad_perm:[1,0,3,2] row_mask:0xf bank_mask:0xf
v_mul_f32 v221, v20, v221
buffer_store_dwordx4 v[88:91], v14, s[24:27], s81 offen offset:0 sc1
v_mfma_f32_16x16x32_bf16 v[252:255], v[40:43], v[132:135], 0
v_mfma_f32_16x16x32_bf16 v[252:255], v[44:47], v[140:143], v[252:255]
v_mfma_f32_16x16x32_bf16 v[252:255], v[24:27], v[148:151], v[252:255]
v_mfma_f32_16x16x32_bf16 v[252:255], v[28:31], v[156:159], v[252:255]
v_cndmask_b32_dpp v66, v198, v194, vcc quad_perm:[1,0,3,2] row_mask:0xf bank_mask:0xf
v_mul_f32 v222, v20, v222
v_cndmask_b32_dpp v65, v197, v193, vcc quad_perm:[1,0,3,2] row_mask:0xf bank_mask:0xf
v_mul_f32 v223, v20, v223
v_cndmask_b32_dpp v67, v199, v195, vcc quad_perm:[1,0,3,2] row_mask:0xf bank_mask:0xf
v_cvt_pk_bf16_f32 v212, v216, v217
v_cvt_pk_bf16_f32 v213, v218, v219
v_cvt_pk_bf16_f32 v214, v220, v221
ds_read_b64_tr_b16 v[32:33], v4 offset:16384
ds_read_b64_tr_b16 v[34:35], v4 offset:18432
ds_read_b64_tr_b16 v[36:37], v4 offset:20480
ds_read_b64_tr_b16 v[38:39], v4 offset:22528
ds_read_b64_tr_b16 v[40:41], v4 offset:24576
ds_read_b64_tr_b16 v[42:43], v4 offset:26624
ds_read_b64_tr_b16 v[44:45], v4 offset:28672
ds_read_b64_tr_b16 v[46:47], v4 offset:30720
s_waitcnt lgkmcnt(0)
v_mfma_f32_16x16x32_bf16 v[224:227], v[32:35], v[160:163], v[224:227]
v_mfma_f32_16x16x32_bf16 v[224:227], v[36:39], v[168:171], v[224:227]
v_mfma_f32_16x16x32_bf16 v[224:227], v[40:43], v[176:179], v[224:227]
v_mfma_f32_16x16x32_bf16 v[224:227], v[44:47], v[184:187], v[224:227]
v_cvt_pk_bf16_f32 v215, v222, v223
s_not_b64 vcc, vcc
v_cndmask_b32_dpp v68, v192, v196, vcc quad_perm:[1,0,3,2] row_mask:0xf bank_mask:0xf
v_cndmask_b32_dpp v70, v194, v198, vcc quad_perm:[1,0,3,2] row_mask:0xf bank_mask:0xf
v_permlane16_swap_b32 v212, v214
buffer_store_dwordx4 v[92:95], v14, s[24:27], s81 offen offset:512 sc1
v_mfma_f32_16x16x32_bf16 v[240:243], v[32:35], v[164:167], v[240:243]
v_mfma_f32_16x16x32_bf16 v[240:243], v[36:39], v[172:175], v[240:243]
v_mfma_f32_16x16x32_bf16 v[240:243], v[40:43], v[180:183], v[240:243]
v_mfma_f32_16x16x32_bf16 v[240:243], v[44:47], v[188:191], v[240:243]
v_cndmask_b32_dpp v69, v193, v197, vcc quad_perm:[1,0,3,2] row_mask:0xf bank_mask:0xf
v_permlane16_swap_b32 v213, v215
v_cndmask_b32_dpp v71, v195, v199, vcc quad_perm:[1,0,3,2] row_mask:0xf bank_mask:0xf
s_not_b64 vcc, vcc
v_cndmask_b32_dpp v72, v212, v208, vcc quad_perm:[1,0,3,2] row_mask:0xf bank_mask:0xf
v_cndmask_b32_dpp v74, v214, v210, vcc quad_perm:[1,0,3,2] row_mask:0xf bank_mask:0xf
ds_read_b64_tr_b16 v[24:25], v6 offset:16384
ds_read_b64_tr_b16 v[26:27], v6 offset:18432
ds_read_b64_tr_b16 v[28:29], v6 offset:20480
ds_read_b64_tr_b16 v[30:31], v6 offset:22528
ds_read_b64_tr_b16 v[32:33], v6 offset:24576
ds_read_b64_tr_b16 v[34:35], v6 offset:26624
ds_read_b64_tr_b16 v[36:37], v6 offset:28672
ds_read_b64_tr_b16 v[38:39], v6 offset:30720
s_waitcnt lgkmcnt(0)
v_mfma_f32_16x16x32_bf16 v[228:231], v[24:27], v[160:163], v[228:231]
v_mfma_f32_16x16x32_bf16 v[228:231], v[28:31], v[168:171], v[228:231]
v_mfma_f32_16x16x32_bf16 v[228:231], v[32:35], v[176:179], v[228:231]
v_mfma_f32_16x16x32_bf16 v[228:231], v[36:39], v[184:187], v[228:231]
v_cndmask_b32_dpp v73, v213, v209, vcc quad_perm:[1,0,3,2] row_mask:0xf bank_mask:0xf
v_cndmask_b32_dpp v75, v215, v211, vcc quad_perm:[1,0,3,2] row_mask:0xf bank_mask:0xf
s_not_b64 vcc, vcc
v_cndmask_b32_dpp v76, v208, v212, vcc quad_perm:[1,0,3,2] row_mask:0xf bank_mask:0xf
v_cndmask_b32_dpp v78, v210, v214, vcc quad_perm:[1,0,3,2] row_mask:0xf bank_mask:0xf
v_cndmask_b32_dpp v77, v209, v213, vcc quad_perm:[1,0,3,2] row_mask:0xf bank_mask:0xf
v_cndmask_b32_dpp v79, v211, v215, vcc quad_perm:[1,0,3,2] row_mask:0xf bank_mask:0xf
v_mfma_f32_16x16x32_bf16 v[244:247], v[24:27], v[164:167], v[244:247]
v_mfma_f32_16x16x32_bf16 v[244:247], v[28:31], v[172:175], v[244:247]
v_mfma_f32_16x16x32_bf16 v[244:247], v[32:35], v[180:183], v[244:247]
v_mfma_f32_16x16x32_bf16 v[244:247], v[36:39], v[188:191], v[244:247]
buffer_store_dwordx4 v[64:67], v14, s[24:27], s82 offen offset:0 sc1
ds_read_b64_tr_b16 v[40:41], v5 offset:16384
ds_read_b64_tr_b16 v[42:43], v5 offset:18432
ds_read_b64_tr_b16 v[44:45], v5 offset:20480
ds_read_b64_tr_b16 v[46:47], v5 offset:22528
ds_read_b64_tr_b16 v[24:25], v5 offset:24576
ds_read_b64_tr_b16 v[26:27], v5 offset:26624
ds_read_b64_tr_b16 v[28:29], v5 offset:28672
ds_read_b64_tr_b16 v[30:31], v5 offset:30720
s_waitcnt lgkmcnt(0)
v_mfma_f32_16x16x32_bf16 v[232:235], v[40:43], v[160:163], v[232:235]
v_mfma_f32_16x16x32_bf16 v[232:235], v[44:47], v[168:171], v[232:235]
v_mfma_f32_16x16x32_bf16 v[232:235], v[24:27], v[176:179], v[232:235]
v_mfma_f32_16x16x32_bf16 v[232:235], v[28:31], v[184:187], v[232:235]
v_mul_f32 v224, v18, v224
v_mul_f32 v225, v18, v225
v_mul_f32 v226, v18, v226
v_mul_f32 v227, v18, v227
v_mul_f32 v228, v18, v228
v_mul_f32 v229, v18, v229
v_mul_f32 v230, v18, v230
v_mul_f32 v231, v18, v231
v_mfma_f32_16x16x32_bf16 v[248:251], v[40:43], v[164:167], v[248:251]
v_mfma_f32_16x16x32_bf16 v[248:251], v[44:47], v[172:175], v[248:251]
v_mfma_f32_16x16x32_bf16 v[248:251], v[24:27], v[180:183], v[248:251]
v_mfma_f32_16x16x32_bf16 v[248:251], v[28:31], v[188:191], v[248:251]
v_cvt_pk_bf16_f32 v224, v224, v225
v_cvt_pk_bf16_f32 v225, v226, v227
v_cvt_pk_bf16_f32 v226, v228, v229
v_cvt_pk_bf16_f32 v227, v230, v231
v_mul_f32 v240, v20, v240
v_mul_f32 v241, v20, v241
buffer_store_dwordx4 v[68:71], v14, s[24:27], s82 offen offset:512 sc1
ds_read_b64_tr_b16 v[32:33], v7 offset:16384
ds_read_b64_tr_b16 v[34:35], v7 offset:18432
ds_read_b64_tr_b16 v[36:37], v7 offset:20480
ds_read_b64_tr_b16 v[38:39], v7 offset:22528
ds_read_b64_tr_b16 v[40:41], v7 offset:24576
ds_read_b64_tr_b16 v[42:43], v7 offset:26624
ds_read_b64_tr_b16 v[44:45], v7 offset:28672
ds_read_b64_tr_b16 v[46:47], v7 offset:30720
s_waitcnt lgkmcnt(0)
s_waitcnt vmcnt(16)
s_barrier
v_mfma_f32_16x16x32_bf16 v[236:239], v[32:35], v[160:163], v[236:239]
v_mfma_f32_16x16x32_bf16 v[236:239], v[36:39], v[168:171], v[236:239]
v_mfma_f32_16x16x32_bf16 v[236:239], v[40:43], v[176:179], v[236:239]
v_mfma_f32_16x16x32_bf16 v[236:239], v[44:47], v[184:187], v[236:239]
v_mul_f32 v242, v20, v242
v_permlane16_swap_b32 v224, v226
v_mul_f32 v243, v20, v243
v_mul_f32 v244, v20, v244
v_mul_f32 v245, v20, v245
v_mul_f32 v246, v20, v246
v_mfma_f32_16x16x32_bf16 v[252:255], v[32:35], v[164:167], v[252:255]
v_mfma_f32_16x16x32_bf16 v[252:255], v[36:39], v[172:175], v[252:255]
v_mfma_f32_16x16x32_bf16 v[252:255], v[40:43], v[180:183], v[252:255]
v_mfma_f32_16x16x32_bf16 v[252:255], v[44:47], v[188:191], v[252:255]
v_mul_f32 v247, v20, v247
v_permlane16_swap_b32 v225, v227
v_cvt_pk_bf16_f32 v240, v240, v241
v_cvt_pk_bf16_f32 v241, v242, v243
v_cvt_pk_bf16_f32 v242, v244, v245
v_cvt_pk_bf16_f32 v243, v246, v247
ds_read_b64_tr_b16 v[24:25], v4 offset:32768
ds_read_b64_tr_b16 v[26:27], v4 offset:34816
ds_read_b64_tr_b16 v[28:29], v4 offset:36864
ds_read_b64_tr_b16 v[30:31], v4 offset:38912
ds_read_b64_tr_b16 v[32:33], v4 offset:40960
ds_read_b64_tr_b16 v[34:35], v4 offset:43008
ds_read_b64_tr_b16 v[36:37], v4 offset:45056
ds_read_b64_tr_b16 v[38:39], v4 offset:47104
s_waitcnt lgkmcnt(0)
v_mfma_f32_16x16x32_bf16 v[192:195], v[24:27], v[128:131], 0
ds_read_b64_tr_b16 v[40:41], v6 offset:32768
v_mfma_f32_16x16x32_bf16 v[192:195], v[28:31], v[136:139], v[192:195]
ds_read_b64_tr_b16 v[42:43], v6 offset:34816
v_mfma_f32_16x16x32_bf16 v[192:195], v[32:35], v[144:147], v[192:195]
ds_read_b64_tr_b16 v[44:45], v6 offset:36864
v_mfma_f32_16x16x32_bf16 v[192:195], v[36:39], v[152:155], v[192:195]
ds_read_b64_tr_b16 v[46:47], v6 offset:38912
s_nop 0
v_permlane16_swap_b32 v240, v242
v_permlane16_swap_b32 v241, v243
buffer_store_dwordx4 v[72:75], v14, s[24:27], s83 offen offset:0 sc1
v_mfma_f32_16x16x32_bf16 v[208:211], v[24:27], v[132:135], 0
ds_read_b64_tr_b16 v[24:25], v6 offset:40960
v_mfma_f32_16x16x32_bf16 v[208:211], v[28:31], v[140:143], v[208:211]
ds_read_b64_tr_b16 v[26:27], v6 offset:43008
v_mfma_f32_16x16x32_bf16 v[208:211], v[32:35], v[148:151], v[208:211]
ds_read_b64_tr_b16 v[28:29], v6 offset:45056
v_mfma_f32_16x16x32_bf16 v[208:211], v[36:39], v[156:159], v[208:211]
ds_read_b64_tr_b16 v[30:31], v6 offset:47104
v_mul_f32 v232, v18, v232
v_mul_f32 v233, v18, v233
v_mul_f32 v234, v18, v234
v_mul_f32 v235, v18, v235
v_mul_f32 v236, v18, v236
v_mul_f32 v237, v18, v237
v_mul_f32 v238, v18, v238
v_mul_f32 v239, v18, v239
s_waitcnt lgkmcnt(0)
v_mfma_f32_16x16x32_bf16 v[196:199], v[40:43], v[128:131], 0
ds_read_b64_tr_b16 v[32:33], v5 offset:32768
v_mfma_f32_16x16x32_bf16 v[196:199], v[44:47], v[136:139], v[196:199]
ds_read_b64_tr_b16 v[34:35], v5 offset:34816
v_mfma_f32_16x16x32_bf16 v[196:199], v[24:27], v[144:147], v[196:199]
ds_read_b64_tr_b16 v[36:37], v5 offset:36864
v_mfma_f32_16x16x32_bf16 v[196:199], v[28:31], v[152:155], v[196:199]
ds_read_b64_tr_b16 v[38:39], v5 offset:38912
v_cvt_pk_bf16_f32 v228, v232, v233
v_cvt_pk_bf16_f32 v229, v234, v235
v_cvt_pk_bf16_f32 v230, v236, v237
v_cvt_pk_bf16_f32 v231, v238, v239
v_mul_f32 v248, v20, v248
v_mul_f32 v249, v20, v249
buffer_store_dwordx4 v[76:79], v14, s[24:27], s83 offen offset:512 sc1
v_mfma_f32_16x16x32_bf16 v[212:215], v[40:43], v[132:135], 0
ds_read_b64_tr_b16 v[40:41], v5 offset:40960
v_mfma_f32_16x16x32_bf16 v[212:215], v[44:47], v[140:143], v[212:215]
ds_read_b64_tr_b16 v[42:43], v5 offset:43008
v_mfma_f32_16x16x32_bf16 v[212:215], v[24:27], v[148:151], v[212:215]
ds_read_b64_tr_b16 v[44:45], v5 offset:45056
v_mfma_f32_16x16x32_bf16 v[212:215], v[28:31], v[156:159], v[212:215]
ds_read_b64_tr_b16 v[46:47], v5 offset:47104
v_mul_f32 v250, v20, v250
v_permlane16_swap_b32 v228, v230
v_mul_f32 v251, v20, v251
v_permlane16_swap_b32 v229, v231
s_waitcnt lgkmcnt(0)
v_mfma_f32_16x16x32_bf16 v[200:203], v[32:35], v[128:131], 0
ds_read_b64_tr_b16 v[24:25], v7 offset:32768
v_mfma_f32_16x16x32_bf16 v[200:203], v[36:39], v[136:139], v[200:203]
ds_read_b64_tr_b16 v[26:27], v7 offset:34816
v_mfma_f32_16x16x32_bf16 v[200:203], v[40:43], v[144:147], v[200:203]
ds_read_b64_tr_b16 v[28:29], v7 offset:36864
v_mfma_f32_16x16x32_bf16 v[200:203], v[44:47], v[152:155], v[200:203]
ds_read_b64_tr_b16 v[30:31], v7 offset:38912
v_mul_f32 v252, v20, v252
s_mov_b64 vcc, s[62:63]
v_cndmask_b32_dpp v96, v228, v224, vcc quad_perm:[1,0,3,2] row_mask:0xf bank_mask:0xf
v_mul_f32 v253, v20, v253
v_cndmask_b32_dpp v98, v230, v226, vcc quad_perm:[1,0,3,2] row_mask:0xf bank_mask:0xf
v_mul_f32 v254, v20, v254
v_cndmask_b32_dpp v97, v229, v225, vcc quad_perm:[1,0,3,2] row_mask:0xf bank_mask:0xf
v_mul_f32 v255, v20, v255
v_mfma_f32_16x16x32_bf16 v[216:219], v[32:35], v[132:135], 0
ds_read_b64_tr_b16 v[32:33], v7 offset:40960
v_mfma_f32_16x16x32_bf16 v[216:219], v[36:39], v[140:143], v[216:219]
ds_read_b64_tr_b16 v[34:35], v7 offset:43008
v_mfma_f32_16x16x32_bf16 v[216:219], v[40:43], v[148:151], v[216:219]
ds_read_b64_tr_b16 v[36:37], v7 offset:45056
v_mfma_f32_16x16x32_bf16 v[216:219], v[44:47], v[156:159], v[216:219]
ds_read_b64_tr_b16 v[38:39], v7 offset:47104
v_cndmask_b32_dpp v99, v231, v227, vcc quad_perm:[1,0,3,2] row_mask:0xf bank_mask:0xf
v_cvt_pk_bf16_f32 v244, v248, v249
v_cvt_pk_bf16_f32 v245, v250, v251
v_cvt_pk_bf16_f32 v246, v252, v253
v_cvt_pk_bf16_f32 v247, v254, v255
s_not_b64 vcc, vcc
v_cndmask_b32_dpp v100, v224, v228, vcc quad_perm:[1,0,3,2] row_mask:0xf bank_mask:0xf
v_cndmask_b32_dpp v102, v226, v230, vcc quad_perm:[1,0,3,2] row_mask:0xf bank_mask:0xf
buffer_store_dwordx4 v[96:99], v14, s[24:27], s84 offen offset:0 sc1
s_waitcnt lgkmcnt(0)
s_waitcnt vmcnt(17)
s_barrier
v_mfma_f32_16x16x32_bf16 v[204:207], v[24:27], v[128:131], 0
ds_read_b64_tr_b16 v[40:41], v4 offset:49152
v_mfma_f32_16x16x32_bf16 v[204:207], v[28:31], v[136:139], v[204:207]
ds_read_b64_tr_b16 v[42:43], v4 offset:51200
v_mfma_f32_16x16x32_bf16 v[204:207], v[32:35], v[144:147], v[204:207]
ds_read_b64_tr_b16 v[44:45], v4 offset:53248
v_mfma_f32_16x16x32_bf16 v[204:207], v[36:39], v[152:155], v[204:207]
ds_read_b64_tr_b16 v[46:47], v4 offset:55296
v_permlane16_swap_b32 v244, v246
v_cndmask_b32_dpp v101, v225, v229, vcc quad_perm:[1,0,3,2] row_mask:0xf bank_mask:0xf
v_permlane16_swap_b32 v245, v247
v_mfma_f32_16x16x32_bf16 v[220:223], v[24:27], v[132:135], 0
ds_read_b64_tr_b16 v[24:25], v4 offset:57344
v_mfma_f32_16x16x32_bf16 v[220:223], v[28:31], v[140:143], v[220:223]
ds_read_b64_tr_b16 v[26:27], v4 offset:59392
v_mfma_f32_16x16x32_bf16 v[220:223], v[32:35], v[148:151], v[220:223]
ds_read_b64_tr_b16 v[28:29], v4 offset:61440
v_mfma_f32_16x16x32_bf16 v[220:223], v[36:39], v[156:159], v[220:223]
ds_read_b64_tr_b16 v[30:31], v4 offset:63488
v_cndmask_b32_dpp v103, v227, v231, vcc quad_perm:[1,0,3,2] row_mask:0xf bank_mask:0xf
s_not_b64 vcc, vcc
v_cndmask_b32_dpp v104, v244, v240, vcc quad_perm:[1,0,3,2] row_mask:0xf bank_mask:0xf
v_cndmask_b32_dpp v106, v246, v242, vcc quad_perm:[1,0,3,2] row_mask:0xf bank_mask:0xf
v_cndmask_b32_dpp v105, v245, v241, vcc quad_perm:[1,0,3,2] row_mask:0xf bank_mask:0xf
v_cndmask_b32_dpp v107, v247, v243, vcc quad_perm:[1,0,3,2] row_mask:0xf bank_mask:0xf
s_not_b64 vcc, vcc
v_cndmask_b32_dpp v108, v240, v244, vcc quad_perm:[1,0,3,2] row_mask:0xf bank_mask:0xf
s_waitcnt lgkmcnt(0)
v_mfma_f32_16x16x32_bf16 v[192:195], v[40:43], v[160:163], v[192:195]
ds_read_b64_tr_b16 v[32:33], v6 offset:49152
v_mfma_f32_16x16x32_bf16 v[192:195], v[44:47], v[168:171], v[192:195]
ds_read_b64_tr_b16 v[34:35], v6 offset:51200
v_mfma_f32_16x16x32_bf16 v[192:195], v[24:27], v[176:179], v[192:195]
ds_read_b64_tr_b16 v[36:37], v6 offset:53248
v_mfma_f32_16x16x32_bf16 v[192:195], v[28:31], v[184:187], v[192:195]
ds_read_b64_tr_b16 v[38:39], v6 offset:55296
v_cndmask_b32_dpp v110, v242, v246, vcc quad_perm:[1,0,3,2] row_mask:0xf bank_mask:0xf
v_cndmask_b32_dpp v109, v241, v245, vcc quad_perm:[1,0,3,2] row_mask:0xf bank_mask:0xf
v_cndmask_b32_dpp v111, v243, v247, vcc quad_perm:[1,0,3,2] row_mask:0xf bank_mask:0xf
buffer_store_dwordx4 v[100:103], v14, s[24:27], s84 offen offset:512 sc1
v_mfma_f32_16x16x32_bf16 v[208:211], v[40:43], v[164:167], v[208:211]
ds_read_b64_tr_b16 v[40:41], v6 offset:57344
v_mfma_f32_16x16x32_bf16 v[208:211], v[44:47], v[172:175], v[208:211]
ds_read_b64_tr_b16 v[42:43], v6 offset:59392
v_mfma_f32_16x16x32_bf16 v[208:211], v[24:27], v[180:183], v[208:211]
ds_read_b64_tr_b16 v[44:45], v6 offset:61440
v_mfma_f32_16x16x32_bf16 v[208:211], v[28:31], v[188:191], v[208:211]
ds_read_b64_tr_b16 v[46:47], v6 offset:63488
s_waitcnt lgkmcnt(0)
v_mfma_f32_16x16x32_bf16 v[196:199], v[32:35], v[160:163], v[196:199]
ds_read_b64_tr_b16 v[24:25], v5 offset:49152
v_mfma_f32_16x16x32_bf16 v[196:199], v[36:39], v[168:171], v[196:199]
ds_read_b64_tr_b16 v[26:27], v5 offset:51200
v_mfma_f32_16x16x32_bf16 v[196:199], v[40:43], v[176:179], v[196:199]
ds_read_b64_tr_b16 v[28:29], v5 offset:53248
v_mfma_f32_16x16x32_bf16 v[196:199], v[44:47], v[184:187], v[196:199]
ds_read_b64_tr_b16 v[30:31], v5 offset:55296
buffer_store_dwordx4 v[104:107], v14, s[24:27], s85 offen offset:0 sc1
v_mfma_f32_16x16x32_bf16 v[212:215], v[32:35], v[164:167], v[212:215]
ds_read_b64_tr_b16 v[32:33], v5 offset:57344
v_mfma_f32_16x16x32_bf16 v[212:215], v[36:39], v[172:175], v[212:215]
ds_read_b64_tr_b16 v[34:35], v5 offset:59392
v_mfma_f32_16x16x32_bf16 v[212:215], v[40:43], v[180:183], v[212:215]
ds_read_b64_tr_b16 v[36:37], v5 offset:61440
v_mfma_f32_16x16x32_bf16 v[212:215], v[44:47], v[188:191], v[212:215]
ds_read_b64_tr_b16 v[38:39], v5 offset:63488
v_mul_f32 v192, v18, v192
v_mul_f32 v193, v18, v193
v_mul_f32 v194, v18, v194
v_mul_f32 v195, v18, v195
v_mul_f32 v196, v18, v196
v_mul_f32 v197, v18, v197
v_mul_f32 v198, v18, v198
v_mul_f32 v199, v18, v199
s_waitcnt lgkmcnt(0)
v_mfma_f32_16x16x32_bf16 v[200:203], v[24:27], v[160:163], v[200:203]
ds_read_b64_tr_b16 v[40:41], v7 offset:49152
v_mfma_f32_16x16x32_bf16 v[200:203], v[28:31], v[168:171], v[200:203]
ds_read_b64_tr_b16 v[42:43], v7 offset:51200
v_mfma_f32_16x16x32_bf16 v[200:203], v[32:35], v[176:179], v[200:203]
ds_read_b64_tr_b16 v[44:45], v7 offset:53248
v_mfma_f32_16x16x32_bf16 v[200:203], v[36:39], v[184:187], v[200:203]
ds_read_b64_tr_b16 v[46:47], v7 offset:55296
v_cvt_pk_bf16_f32 v192, v192, v193
v_cvt_pk_bf16_f32 v193, v194, v195
v_cvt_pk_bf16_f32 v194, v196, v197
v_cvt_pk_bf16_f32 v195, v198, v199
v_mul_f32 v208, v20, v208
v_mul_f32 v209, v20, v209
v_mfma_f32_16x16x32_bf16 v[216:219], v[24:27], v[164:167], v[216:219]
ds_read_b64_tr_b16 v[24:25], v7 offset:57344
v_mfma_f32_16x16x32_bf16 v[216:219], v[28:31], v[172:175], v[216:219]
ds_read_b64_tr_b16 v[26:27], v7 offset:59392
v_mfma_f32_16x16x32_bf16 v[216:219], v[32:35], v[180:183], v[216:219]
ds_read_b64_tr_b16 v[28:29], v7 offset:61440
v_mfma_f32_16x16x32_bf16 v[216:219], v[36:39], v[188:191], v[216:219]
ds_read_b64_tr_b16 v[30:31], v7 offset:63488
v_mul_f32 v210, v20, v210
v_permlane16_swap_b32 v192, v194
v_mul_f32 v211, v20, v211
v_mul_f32 v212, v20, v212
v_mul_f32 v213, v20, v213
v_mul_f32 v214, v20, v214
buffer_store_dwordx4 v[108:111], v14, s[24:27], s85 offen offset:512 sc1
s_waitcnt lgkmcnt(0)
v_mfma_f32_16x16x32_bf16 v[204:207], v[40:43], v[160:163], v[204:207]
v_mfma_f32_16x16x32_bf16 v[204:207], v[44:47], v[168:171], v[204:207]
v_mfma_f32_16x16x32_bf16 v[204:207], v[24:27], v[176:179], v[204:207]
v_mfma_f32_16x16x32_bf16 v[204:207], v[28:31], v[184:187], v[204:207]
v_mul_f32 v215, v20, v215
v_permlane16_swap_b32 v193, v195
v_cvt_pk_bf16_f32 v208, v208, v209
v_cvt_pk_bf16_f32 v209, v210, v211
v_cvt_pk_bf16_f32 v210, v212, v213
v_cvt_pk_bf16_f32 v211, v214, v215
v_mfma_f32_16x16x32_bf16 v[220:223], v[40:43], v[164:167], v[220:223]
v_mfma_f32_16x16x32_bf16 v[220:223], v[44:47], v[172:175], v[220:223]
v_mfma_f32_16x16x32_bf16 v[220:223], v[24:27], v[180:183], v[220:223]
v_mfma_f32_16x16x32_bf16 v[220:223], v[28:31], v[188:191], v[220:223]
s_nop 0
v_permlane16_swap_b32 v208, v210
v_permlane16_swap_b32 v209, v211
s_nop 4
v_mul_f32 v200, v18, v200
v_mul_f32 v201, v18, v201
v_mul_f32 v202, v18, v202
v_mul_f32 v203, v18, v203
v_mul_f32 v204, v18, v204
v_mul_f32 v205, v18, v205
v_mul_f32 v206, v18, v206
v_mul_f32 v207, v18, v207
v_cvt_pk_bf16_f32 v196, v200, v201
v_cvt_pk_bf16_f32 v197, v202, v203
v_cvt_pk_bf16_f32 v198, v204, v205
v_cvt_pk_bf16_f32 v199, v206, v207
v_mul_f32 v216, v20, v216
v_mul_f32 v217, v20, v217
v_permlane16_swap_b32 v196, v198
v_mul_f32 v218, v20, v218
v_permlane16_swap_b32 v197, v199
v_mul_f32 v219, v20, v219
v_mul_f32 v220, v20, v220
s_mov_b64 vcc, s[62:63]
v_cndmask_b32_dpp v112, v196, v192, vcc quad_perm:[1,0,3,2] row_mask:0xf bank_mask:0xf
v_mul_f32 v221, v20, v221
v_cndmask_b32_dpp v114, v198, v194, vcc quad_perm:[1,0,3,2] row_mask:0xf bank_mask:0xf
v_mul_f32 v222, v20, v222
v_cndmask_b32_dpp v113, v197, v193, vcc quad_perm:[1,0,3,2] row_mask:0xf bank_mask:0xf
v_mul_f32 v223, v20, v223
v_cndmask_b32_dpp v115, v199, v195, vcc quad_perm:[1,0,3,2] row_mask:0xf bank_mask:0xf
v_cvt_pk_bf16_f32 v212, v216, v217
v_cvt_pk_bf16_f32 v213, v218, v219
v_cvt_pk_bf16_f32 v214, v220, v221
v_cvt_pk_bf16_f32 v215, v222, v223
buffer_store_dwordx4 v[112:115], v14, s[24:27], s86 offen offset:0 sc1
s_not_b64 vcc, vcc
v_cndmask_b32_dpp v116, v192, v196, vcc quad_perm:[1,0,3,2] row_mask:0xf bank_mask:0xf
v_cndmask_b32_dpp v118, v194, v198, vcc quad_perm:[1,0,3,2] row_mask:0xf bank_mask:0xf
v_permlane16_swap_b32 v212, v214
v_cndmask_b32_dpp v117, v193, v197, vcc quad_perm:[1,0,3,2] row_mask:0xf bank_mask:0xf
v_permlane16_swap_b32 v213, v215
v_cndmask_b32_dpp v119, v195, v199, vcc quad_perm:[1,0,3,2] row_mask:0xf bank_mask:0xf
buffer_store_dwordx4 v[116:119], v14, s[24:27], s86 offen offset:512 sc1
s_not_b64 vcc, vcc
v_cndmask_b32_dpp v120, v212, v208, vcc quad_perm:[1,0,3,2] row_mask:0xf bank_mask:0xf
v_cndmask_b32_dpp v122, v214, v210, vcc quad_perm:[1,0,3,2] row_mask:0xf bank_mask:0xf
v_cndmask_b32_dpp v121, v213, v209, vcc quad_perm:[1,0,3,2] row_mask:0xf bank_mask:0xf
v_cndmask_b32_dpp v123, v215, v211, vcc quad_perm:[1,0,3,2] row_mask:0xf bank_mask:0xf
buffer_store_dwordx4 v[120:123], v14, s[24:27], s87 offen offset:0 sc1
s_not_b64 vcc, vcc
v_cndmask_b32_dpp v124, v208, v212, vcc quad_perm:[1,0,3,2] row_mask:0xf bank_mask:0xf
v_cndmask_b32_dpp v126, v210, v214, vcc quad_perm:[1,0,3,2] row_mask:0xf bank_mask:0xf
v_cndmask_b32_dpp v125, v209, v213, vcc quad_perm:[1,0,3,2] row_mask:0xf bank_mask:0xf
v_cndmask_b32_dpp v127, v211, v215, vcc quad_perm:[1,0,3,2] row_mask:0xf bank_mask:0xf
buffer_store_dwordx4 v[124:127], v14, s[24:27], s87 offen offset:512 sc1
L_end:
s_endpgm
L_last:
.section .rodata,"a"
.p2align 6
.amdhsa_kernel standalone__mha_softmax__near_ridge_kernel
  .amdhsa_next_free_vgpr 256
  .amdhsa_next_free_sgpr 102
  .amdhsa_accum_offset 256
  .amdhsa_group_segment_fixed_size 0
  .amdhsa_kernarg_size 48
  .amdhsa_user_sgpr_count 2
  .amdhsa_user_sgpr_kernarg_segment_ptr 1
  .amdhsa_system_sgpr_workgroup_id_x 1
.end_amdhsa_kernel
```
